```python
import torch

def _softmax(x, axis=-1):
    return torch.softmax(x, dim=axis)
def _gelu(x):
    return torch.nn.functional.gelu(x, approximate="tanh")
def _silu(x):
    return torch.nn.functional.silu(x)
def _sigmoid(x):
    return torch.sigmoid(x)
def _layernorm(x, axis=-1, eps=1e-5):
    m = x.mean(dim=axis, keepdim=True)
    v = x.var(dim=axis, keepdim=True, unbiased=False)
    return (x - m) / torch.sqrt(v + eps)
def _scatter_add(tgt, idx, src, axis=0):
    return tgt.clone().index_add_(axis, idx, src)
def _segment_sum(src, seg, n):
    out = torch.zeros((n,) + src.shape[1:], dtype=src.dtype)
    return out.index_add_(0, seg, src)
def _pad(x, pw):
    flat = tuple(v for pair in reversed(pw) for v in pair)
    return torch.nn.functional.pad(x, flat)

kernel_name = 'standalone__grouped_kv_mqa__prompt'

def setup_inputs():

    _w = (lambda a: (lambda t: t.to(torch.bfloat16) if t.is_floating_point() else t)(torch.as_tensor(a)))
    B, S, D, H = 1, 2048, 640, 32
    Dh = D // H
    return {
        "x": _w((lambda *s: torch.randn(*s, dtype=torch.bfloat16) * 0.05)(B, S, D)),
        "wq": _w((lambda *s: torch.randn(*s, dtype=torch.bfloat16) * 0.8)(D, H * Dh)),
        "wk": _w((lambda *s: torch.randn(*s, dtype=torch.bfloat16) * 0.8)(D, Dh)),
        "wv": _w((lambda *s: torch.randn(*s, dtype=torch.bfloat16) * 0.05)(D, Dh)),
        "wo": _w((lambda *s: torch.randn(*s, dtype=torch.bfloat16) * 0.05)(H * Dh, D)),
    }

def reference(x, wq, wk, wv, wo):
    B, S, D = x.shape
    H = 32
    Dh = D // H
    q = (lambda x, *d: x.permute(*d))((x @ wq).reshape(B, S, H, Dh), 0, 2, 1, 3)
    k = x @ wk
    v = x @ wv
    scores = torch.einsum("bhqd,bkd->bhqk", q, k) * (Dh ** -0.5)
    p = _softmax(scores, axis=-1)
    o = torch.einsum("bhqk,bkd->bhqd", p, v)
    return (lambda x, *d: x.permute(*d))(o, 0, 2, 1, 3).reshape(B, S, H * Dh) @ wo
```

```asm
; @launch grid=(256,1,1) block=(512,1,1) lds=163840
.amdgcn_target "amdgcn-amd-amdhsa--gfx950"
.text
.globl standalone__grouped_kv_mqa__prompt_kernel
.p2align 12
.type standalone__grouped_kv_mqa__prompt_kernel,@function
standalone__grouped_kv_mqa__prompt_kernel:
  s_getpc_b64 s[26:27]
L_pc:
  s_cmp_ge_u32 s2, 256
  s_cbranch_scc1 L_end
  s_load_dwordx16 s[4:19], s[0:1], 0
  v_lshrrev_b32 v1, 6, v0
  v_and_b32 v0, 63, v0
  s_lshr_b32 s25, s2, 3
  s_and_b32 s3, s2, 7
  v_readfirstlane_b32 s22, v1
  s_lshl_b32 s20, s3, 2
  s_and_b32 s53, s25, 3
  s_add_u32 s20, s20, s53
  s_lshr_b32 s21, s2, 5
  s_lshr_b32 s55, s2, 6
  s_and_b32 s54, s21, 1
  s_and_b32 s23, s22, 3
  s_lshr_b32 s24, s22, 2
  s_sub_u32 s48, s23, s55
  s_and_b32 s48, s48, 3
  s_cbranch_scc0 L_kva
  v_lshlrev_b32 v144, 7, v0
  s_cmp_eq_u32 s24, 0
  s_cbranch_scc0 L_hlp
  s_and_b32 s52, s48, 1
  s_cbranch_scc1 L_setup
  s_mov_b32 s34, 819200
  s_mov_b32 s35, 0x20000
  s_mul_i32 s27, s25, 12800
  s_lshr_b32 s26, s48, 1
  s_mul_i32 s26, s26, 6400
  s_add_u32 s27, s27, s26
  s_mul_i32 s26, s2, 3200
  s_add_u32 s26, s26, 0
  s_cmp_eq_u32 s48, 2
  s_cselect_b32 s27, s26, s27
  s_movk_i32 s26, 6272
  s_cmovk_i32 s26, 3196
  v_min_u32 v4, s26, v144
  s_waitcnt lgkmcnt(0)
  s_mov_b32 s32, s6
  s_and_b32 s33, s7, 0xffff
  buffer_load_dword v235, v4, s[32:35], s27 offen
  s_branch L_setup
L_kva:
  s_cmp_eq_u32 s24, 0
  s_cbranch_scc0 L_kv1
  s_mul_i32 s52, s25, 1152
  v_lshlrev_b32 v144, 7, v0
  v_min_u32 v1, 1024, v144
  v_add_u32 v1, s52, v1
  v_min_u32 v1, L_codeend-L_pc-4, v1
  global_load_dword v235, v1, s[26:27]
  s_mov_b32 s38, 25600
  s_mov_b32 s39, 0x20000
  s_mov_b32 s42, 4194304
  s_mov_b32 s43, 0x20000
  s_lshl_b32 s26, s55, 2
  s_add_u32 s26, s26, s53
  s_mul_i32 s26, s26, 1664
  v_min_u32 v7, 1536, v144
  s_lshr_b32 s52, s21, 2
  s_lshl1_add_u32 s52, s20, s52
  s_lshl_b32 s56, s52, 7
  s_lshl2_add_u32 s52, s52, 0
  s_and_b32 s57, s21, 3
  s_add_u32 s52, s52, s57
  s_mul_i32 s52, s52, 768
  s_lshl_b32 s57, s3, 13
  s_add_u32 s52, s52, s57
  s_sub_u32 s56, s56, s52
  s_add_u32 s56, s56, 262144
  s_add_u32 s52, s52, 524288
  v_cmp_gt_u32 vcc, 6, v0
  v_mov_b32 v8, s56
  v_cndmask_b32 v8, v8, v144, vcc
  s_cmp_eq_u32 s54, 1
  s_waitcnt lgkmcnt(0)
  s_cselect_b32 s36, s10, s8
  s_cselect_b32 s37, s11, s9
  s_and_b32 s37, s37, 0xffff
  buffer_load_dword v235, v7, s[36:39], s26 offen
  s_load_dword s62, s[18:19], 294912
  s_mov_b32 s40, s18
  s_and_b32 s41, s19, 0xffff
  buffer_load_dword v235, v8, s[40:43], s52 offen sc1
  s_branch L_setup
L_kv1:
  s_setprio 3
  v_lshrrev_b32 v1, 3, v0
  v_and_b32 v2, 7, v0
  v_and_b32 v3, 6, v1
  v_xor_b32 v2, v2, v3
  v_mul_u32_u24 v153, 1280, v1
  v_lshl_add_u32 v153, v2, 4, v153
  s_lshl_b32 s55, s20, 2
  s_add_u32 s55, s55, s23
  s_lshl_b32 s55, s55, 1
  s_add_u32 s55, s55, s54
  s_mul_i32 s55, s55, 10240
  s_lshl_b32 s52, s54, 10
  s_add_u32 m0, s52, 128512
  s_mov_b32 s30, 2621440
  s_mov_b32 s31, 0x20000
  v_lshlrev_b32 v144, 7, v0
  s_waitcnt lgkmcnt(0)
  s_mov_b32 s28, s4
  s_and_b32 s29, s5, 0xffff
  buffer_load_dwordx4 v153, s[28:31], s55 offen nt lds
  s_add_u32 m0, m0, 2048
  s_add_u32 s55, s55, 128
  buffer_load_dwordx4 v153, s[28:31], s55 offen nt lds
  s_add_u32 m0, m0, 2048
  s_add_u32 s55, s55, 128
  buffer_load_dwordx4 v153, s[28:31], s55 offen nt lds
  s_add_u32 m0, m0, 2048
  s_add_u32 s55, s55, 128
  buffer_load_dwordx4 v153, s[28:31], s55 offen nt lds
  s_add_u32 m0, m0, 2048
  s_add_u32 s55, s55, 128
  buffer_load_dwordx4 v153, s[28:31], s55 offen nt lds
  s_add_u32 m0, m0, 2048
  s_add_u32 s55, s55, 128
  buffer_load_dwordx4 v153, s[28:31], s55 offen nt lds
  s_add_u32 m0, m0, 2048
  s_add_u32 s55, s55, 128
  buffer_load_dwordx4 v153, s[28:31], s55 offen nt lds
  s_add_u32 m0, m0, 2048
  s_add_u32 s55, s55, 128
  buffer_load_dwordx4 v153, s[28:31], s55 offen nt lds
  s_add_u32 m0, m0, 2048
  s_add_u32 s55, s55, 128
  buffer_load_dwordx4 v153, s[28:31], s55 offen nt lds
  s_add_u32 m0, m0, 2048
  s_add_u32 s55, s55, 128
  buffer_load_dwordx4 v153, s[28:31], s55 offen nt lds
  s_load_dword s62, s[18:19], 294912
  s_and_b32 s54, s21, 1
  s_cselect_b32 s36, s10, s8
  s_cselect_b32 s37, s11, s9
  s_and_b32 s37, s37, 0xffff
  s_mov_b32 s34, 819200
  s_mov_b32 s35, 0x20000
  s_mov_b32 s38, 25600
  s_mov_b32 s39, 0x20000
  s_mov_b32 s42, 4194304
  s_mov_b32 s43, 0x20000
  s_mov_b32 s32, s6
  s_and_b32 s33, s7, 0xffff
  s_mov_b32 s40, s18
  s_and_b32 s41, s19, 0xffff
  s_getreg_b32 s16, hwreg(HW_REG_XCC_ID, 0, 4)
  s_mul_i32 s27, s25, 12800
  s_add_u32 s27, s27, 409600
  v_min_u32 v4, 6272, v144
  v_lshlrev_b32 v6, 4, v0
  v_and_b32 v13, 15, v0
  v_lshrrev_b32 v14, 4, v0
  v_lshrrev_b32 v1, 3, v13
  v_lshlrev_b32 v1, 10, v1
  v_and_b32 v2, 7, v13
  v_lshl_add_u32 v1, v2, 7, v1
  v_and_b32 v2, 6, v13
  v_xor_b32 v2, v2, v14
  v_lshl_add_u32 v1, v2, 4, v1
  v_add_u32 v154, 128512, v1
  v_xor_b32 v155, 64, v154
  s_getpc_b64 s[56:57]
L_dpc2:
  s_add_u32 s56, s56, L_tbl-L_dpc2
  s_addc_u32 s57, s57, 0
  v_mov_b32 v9, 0
  s_and_b32 s54, s21, 1
  s_lshl_b32 s52, s20, 1
  s_lshr_b32 s53, s23, 1
  s_add_u32 s7, s52, s53
  s_mul_i32 s6, s7, 3072
  s_lshl_b32 s55, s3, 13
  s_add_u32 s6, s6, s55
  s_and_b32 s53, s23, 1
  s_lshl_b32 s7, s7, 7
  s_lshl_b32 s55, s53, 3
  s_add_u32 s7, s7, s55
  s_lshl_b32 s55, s54, 2
  s_add_u32 s7, s7, s55
  s_add_u32 s7, s7, 262144
  v_lshrrev_b32 v7, 1, v14
  v_and_b32 v8, 1, v14
  v_mov_b32 v112, 0x3f803f80
  s_cmp_eq_u32 s54, 1
  s_cbranch_scc1 L_vpre
  s_mov_b32 s4, 1051011932
  s_lshl_b32 s53, s53, 4
  v_add_u32 v115, s53, v13
  v_lshl_add_u32 v114, v7, 5, v115
  v_lshl_add_u32 v115, v14, 5, v115
  v_lshlrev_b32 v114, 4, v114
  v_lshlrev_b32 v115, 3, v115
  v_lshl_add_u32 v114, v8, 3, v114
  v_add_u32 v115, 1024, v115
  v_mov_b32 v113, 0x3f80
  s_mov_b64 s[8:9], 0xffff
  s_mov_b32 s10, -1
  s_mov_b32 s11, 0
  s_branch L_vpre2
L_vpre:
  s_mov_b32 s4, 1.0
  s_mul_i32 s53, s53, 768
  s_add_u32 s53, s53, 1536
  v_cmp_eq_u32 vcc, 4, v13
  v_mul_u32_u24 v114, 24, v7
  v_add_u32 v114, v114, v13
  v_cndmask_b32 v112, 0, v112, vcc
  v_lshl_add_u32 v114, v114, 4, s53
  v_lshl_add_u32 v114, v8, 3, v114
  v_add_u32 v115, 256, v114
  v_mov_b32 v113, v112
  s_mov_b32 s8, 0x000f000f
  s_mov_b32 s9, 0x000f000f
  s_mov_b32 s10, 0x00ff00ff
  s_mov_b32 s11, 0x00ff00ff
L_vpre2:
  s_mov_b32 s5, s4
  v_bfe_u32 v1, v0, 2, 2
  v_and_b32 v2, 3, v0
  v_lshl_add_u32 v3, v14, 3, v1
  v_mul_u32_u24 v116, 40, v3
  v_lshl_add_u32 v116, v2, 3, v116
  v_add_u32 v116, 102400, v116
  s_xor_b32 s54, s54, 1
  s_lshl_b32 s55, s20, 2
  s_add_u32 s55, s55, s23
  s_lshl_b32 s55, s55, 1
  s_add_u32 s55, s55, s54
  s_mul_i32 s55, s55, 10240
  s_lshl_b32 s52, s54, 10
  s_add_u32 m0, s52, 128512
  s_nop 0
  s_mov_b32 m0, 102400
  s_movk_i32 s26, 0
  buffer_load_dwordx4 v6, s[36:39], s26 offen offset:0 lds
  buffer_load_dwordx4 v6, s[36:39], s26 offen offset:1024 lds
  buffer_load_dwordx4 v6, s[36:39], s26 offen offset:2048 lds
  buffer_load_dwordx4 v6, s[36:39], s26 offen offset:3072 lds
  s_mov_b32 m0, 106496
  s_movk_i32 s26, 4096
  buffer_load_dwordx4 v6, s[36:39], s26 offen offset:0 lds
  buffer_load_dwordx4 v6, s[36:39], s26 offen offset:1024 lds
  buffer_load_dwordx4 v6, s[36:39], s26 offen offset:2048 lds
  buffer_load_dwordx4 v6, s[36:39], s26 offen offset:3072 lds
  s_mov_b32 m0, 110592
  s_movk_i32 s26, 8192
  buffer_load_dwordx4 v6, s[36:39], s26 offen offset:0 lds
  buffer_load_dwordx4 v6, s[36:39], s26 offen offset:1024 lds
  buffer_load_dwordx4 v6, s[36:39], s26 offen offset:2048 lds
  buffer_load_dwordx4 v6, s[36:39], s26 offen offset:3072 lds
  s_mov_b32 m0, 114688
  s_movk_i32 s26, 12288
  buffer_load_dwordx4 v6, s[36:39], s26 offen offset:0 lds
  buffer_load_dwordx4 v6, s[36:39], s26 offen offset:1024 lds
  buffer_load_dwordx4 v6, s[36:39], s26 offen offset:2048 lds
  buffer_load_dwordx4 v6, s[36:39], s26 offen offset:3072 lds
  s_mov_b32 m0, 118784
  s_movk_i32 s26, 16384
  buffer_load_dwordx4 v6, s[36:39], s26 offen offset:0 lds
  buffer_load_dwordx4 v6, s[36:39], s26 offen offset:1024 lds
  buffer_load_dwordx4 v6, s[36:39], s26 offen offset:2048 lds
  buffer_load_dwordx4 v6, s[36:39], s26 offen offset:3072 lds
  s_mov_b32 m0, 122880
  s_movk_i32 s26, 20480
  buffer_load_dwordx4 v6, s[36:39], s26 offen offset:0 lds
  buffer_load_dwordx4 v6, s[36:39], s26 offen offset:1024 lds
  buffer_load_dwordx4 v6, s[36:39], s26 offen offset:2048 lds
  buffer_load_dwordx4 v6, s[36:39], s26 offen offset:3072 lds
  s_mov_b32 m0, 126976
  s_movk_i32 s26, 24576
  buffer_load_dwordx4 v6, s[36:39], s26 offen offset:0 lds
  s_add_u32 m0, s52, 128512
  s_nop 0
  buffer_load_dwordx4 v153, s[28:31], s55 offen lds
  s_add_u32 m0, s52, 130560
  s_add_u32 s55, s55, 128
  buffer_load_dwordx4 v153, s[28:31], s55 offen lds
  s_add_u32 m0, s52, 132608
  s_add_u32 s55, s55, 128
  buffer_load_dwordx4 v153, s[28:31], s55 offen lds
  s_add_u32 m0, s52, 134656
  s_add_u32 s55, s55, 128
  buffer_load_dwordx4 v153, s[28:31], s55 offen lds
  s_add_u32 m0, s52, 136704
  s_add_u32 s55, s55, 128
  buffer_load_dwordx4 v153, s[28:31], s55 offen lds
  s_add_u32 m0, s52, 138752
  s_add_u32 s55, s55, 128
  buffer_load_dwordx4 v153, s[28:31], s55 offen lds
  s_add_u32 m0, s52, 140800
  s_add_u32 s55, s55, 128
  buffer_load_dwordx4 v153, s[28:31], s55 offen lds
  s_add_u32 m0, s52, 142848
  s_add_u32 s55, s55, 128
  buffer_load_dwordx4 v153, s[28:31], s55 offen lds
  s_add_u32 m0, s52, 144896
  s_add_u32 s55, s55, 128
  buffer_load_dwordx4 v153, s[28:31], s55 offen lds
  s_add_u32 m0, s52, 146944
  s_add_u32 s55, s55, 128
  buffer_load_dwordx4 v153, s[28:31], s55 offen lds
  s_waitcnt lgkmcnt(0)
  s_barrier
  s_add_u32 s62, s62, 0x9e3779b0
  s_andn2_b32 s62, s62, 15
  s_mov_b32 s63, s62
  s_lshl2_add_u32 m0, s23, 163364
  s_mov_b64 exec, 1
  global_load_lds_dword v9, s[56:57] offset:12
  s_mov_b64 exec, -1
  s_add_u32 s52, s6, 524288
  s_add_u32 s53, s7, 524288
  s_waitcnt vmcnt(10)
  ds_read_b128 v[16:19], v154 offset:0
  ds_read_b128 v[20:23], v155 offset:0
  s_waitcnt vmcnt(9)
  ds_read_b128 v[24:27], v154 offset:2048
  ds_read_b128 v[28:31], v155 offset:2048
  s_bitcmp1_b32 s21, 0
  s_cbranch_scc1 L_vmm
  ds_read_b64_tr_b16 v[96:97], v116 offset:0
  ds_read_b64_tr_b16 v[98:99], v116 offset:160
  ds_read_b64_tr_b16 v[100:101], v116 offset:32
  ds_read_b64_tr_b16 v[102:103], v116 offset:192
  ds_read_b64_tr_b16 v[104:105], v116 offset:1280
  ds_read_b64_tr_b16 v[106:107], v116 offset:1440
  ds_read_b64_tr_b16 v[108:109], v116 offset:1312
  ds_read_b64_tr_b16 v[110:111], v116 offset:1472
  ds_read_b64_tr_b16 v[164:165], v116 offset:2560
  ds_read_b64_tr_b16 v[166:167], v116 offset:2720
  ds_read_b64_tr_b16 v[168:169], v116 offset:2592
  ds_read_b64_tr_b16 v[170:171], v116 offset:2752
  s_waitcnt lgkmcnt(8)
  v_mfma_f32_16x16x32_bf16 v[156:159], v[96:99], v[16:19], 0
  v_mfma_f32_16x16x32_bf16 v[160:163], v[100:103], v[16:19], 0
  s_waitcnt vmcnt(8)
  ds_read_b128 v[32:35], v154 offset:4096
  ds_read_b64_tr_b16 v[176:177], v116 offset:3840
  ds_read_b64_tr_b16 v[178:179], v116 offset:4000
  ds_read_b64_tr_b16 v[180:181], v116 offset:3872
  ds_read_b64_tr_b16 v[182:183], v116 offset:4032
  s_waitcnt lgkmcnt(9)
  v_mfma_f32_16x16x32_bf16 v[156:159], v[104:107], v[20:23], v[156:159]
  v_mfma_f32_16x16x32_bf16 v[160:163], v[108:111], v[20:23], v[160:163]
  ds_read_b128 v[36:39], v155 offset:4096
  ds_read_b64_tr_b16 v[96:97], v116 offset:5120
  ds_read_b64_tr_b16 v[98:99], v116 offset:5280
  ds_read_b64_tr_b16 v[100:101], v116 offset:5152
  ds_read_b64_tr_b16 v[102:103], v116 offset:5312
  s_waitcnt lgkmcnt(10)
  v_mfma_f32_16x16x32_bf16 v[156:159], v[164:167], v[24:27], v[156:159]
  v_mfma_f32_16x16x32_bf16 v[160:163], v[168:171], v[24:27], v[160:163]
  s_waitcnt vmcnt(7)
  ds_read_b128 v[40:43], v154 offset:6144
  ds_read_b64_tr_b16 v[104:105], v116 offset:6400
  ds_read_b64_tr_b16 v[106:107], v116 offset:6560
  ds_read_b64_tr_b16 v[108:109], v116 offset:6432
  ds_read_b64_tr_b16 v[110:111], v116 offset:6592
  s_waitcnt lgkmcnt(10)
  v_mfma_f32_16x16x32_bf16 v[156:159], v[176:179], v[28:31], v[156:159]
  v_mfma_f32_16x16x32_bf16 v[160:163], v[180:183], v[28:31], v[160:163]
  ds_read_b128 v[44:47], v155 offset:6144
  ds_read_b64_tr_b16 v[164:165], v116 offset:7680
  ds_read_b64_tr_b16 v[166:167], v116 offset:7840
  ds_read_b64_tr_b16 v[168:169], v116 offset:7712
  ds_read_b64_tr_b16 v[170:171], v116 offset:7872
  s_waitcnt lgkmcnt(10)
  v_mfma_f32_16x16x32_bf16 v[156:159], v[96:99], v[32:35], v[156:159]
  v_mfma_f32_16x16x32_bf16 v[160:163], v[100:103], v[32:35], v[160:163]
  s_waitcnt vmcnt(6)
  ds_read_b128 v[48:51], v154 offset:8192
  ds_read_b64_tr_b16 v[176:177], v116 offset:8960
  ds_read_b64_tr_b16 v[178:179], v116 offset:9120
  ds_read_b64_tr_b16 v[180:181], v116 offset:8992
  ds_read_b64_tr_b16 v[182:183], v116 offset:9152
  s_waitcnt lgkmcnt(10)
  v_mfma_f32_16x16x32_bf16 v[156:159], v[104:107], v[36:39], v[156:159]
  v_mfma_f32_16x16x32_bf16 v[160:163], v[108:111], v[36:39], v[160:163]
  ds_read_b128 v[52:55], v155 offset:8192
  ds_read_b64_tr_b16 v[96:97], v116 offset:10240
  ds_read_b64_tr_b16 v[98:99], v116 offset:10400
  ds_read_b64_tr_b16 v[100:101], v116 offset:10272
  ds_read_b64_tr_b16 v[102:103], v116 offset:10432
  s_waitcnt lgkmcnt(10)
  v_mfma_f32_16x16x32_bf16 v[156:159], v[164:167], v[40:43], v[156:159]
  v_mfma_f32_16x16x32_bf16 v[160:163], v[168:171], v[40:43], v[160:163]
  s_waitcnt vmcnt(5)
  ds_read_b128 v[56:59], v154 offset:10240
  ds_read_b64_tr_b16 v[104:105], v116 offset:11520
  ds_read_b64_tr_b16 v[106:107], v116 offset:11680
  ds_read_b64_tr_b16 v[108:109], v116 offset:11552
  ds_read_b64_tr_b16 v[110:111], v116 offset:11712
  s_waitcnt lgkmcnt(10)
  v_mfma_f32_16x16x32_bf16 v[156:159], v[176:179], v[44:47], v[156:159]
  v_mfma_f32_16x16x32_bf16 v[160:163], v[180:183], v[44:47], v[160:163]
  ds_read_b128 v[60:63], v155 offset:10240
  ds_read_b64_tr_b16 v[164:165], v116 offset:12800
  ds_read_b64_tr_b16 v[166:167], v116 offset:12960
  ds_read_b64_tr_b16 v[168:169], v116 offset:12832
  ds_read_b64_tr_b16 v[170:171], v116 offset:12992
  s_waitcnt lgkmcnt(10)
  v_mfma_f32_16x16x32_bf16 v[156:159], v[96:99], v[48:51], v[156:159]
  v_mfma_f32_16x16x32_bf16 v[160:163], v[100:103], v[48:51], v[160:163]
  s_waitcnt vmcnt(4)
  ds_read_b128 v[64:67], v154 offset:12288
  ds_read_b64_tr_b16 v[176:177], v116 offset:14080
  ds_read_b64_tr_b16 v[178:179], v116 offset:14240
  ds_read_b64_tr_b16 v[180:181], v116 offset:14112
  ds_read_b64_tr_b16 v[182:183], v116 offset:14272
  s_waitcnt lgkmcnt(10)
  v_mfma_f32_16x16x32_bf16 v[156:159], v[104:107], v[52:55], v[156:159]
  v_mfma_f32_16x16x32_bf16 v[160:163], v[108:111], v[52:55], v[160:163]
  ds_read_b128 v[68:71], v155 offset:12288
  ds_read_b64_tr_b16 v[96:97], v116 offset:15360
  ds_read_b64_tr_b16 v[98:99], v116 offset:15520
  ds_read_b64_tr_b16 v[100:101], v116 offset:15392
  ds_read_b64_tr_b16 v[102:103], v116 offset:15552
  s_waitcnt lgkmcnt(10)
  v_mfma_f32_16x16x32_bf16 v[156:159], v[164:167], v[56:59], v[156:159]
  v_mfma_f32_16x16x32_bf16 v[160:163], v[168:171], v[56:59], v[160:163]
  s_waitcnt vmcnt(3)
  ds_read_b128 v[72:75], v154 offset:14336
  ds_read_b64_tr_b16 v[104:105], v116 offset:16640
  ds_read_b64_tr_b16 v[106:107], v116 offset:16800
  ds_read_b64_tr_b16 v[108:109], v116 offset:16672
  ds_read_b64_tr_b16 v[110:111], v116 offset:16832
  s_waitcnt lgkmcnt(10)
  v_mfma_f32_16x16x32_bf16 v[156:159], v[176:179], v[60:63], v[156:159]
  v_mfma_f32_16x16x32_bf16 v[160:163], v[180:183], v[60:63], v[160:163]
  ds_read_b128 v[76:79], v155 offset:14336
  ds_read_b64_tr_b16 v[164:165], v116 offset:17920
  ds_read_b64_tr_b16 v[166:167], v116 offset:18080
  ds_read_b64_tr_b16 v[168:169], v116 offset:17952
  ds_read_b64_tr_b16 v[170:171], v116 offset:18112
  s_waitcnt lgkmcnt(10)
  v_mfma_f32_16x16x32_bf16 v[156:159], v[96:99], v[64:67], v[156:159]
  v_mfma_f32_16x16x32_bf16 v[160:163], v[100:103], v[64:67], v[160:163]
  s_waitcnt vmcnt(2)
  ds_read_b128 v[80:83], v154 offset:16384
  ds_read_b64_tr_b16 v[176:177], v116 offset:19200
  ds_read_b64_tr_b16 v[178:179], v116 offset:19360
  ds_read_b64_tr_b16 v[180:181], v116 offset:19232
  ds_read_b64_tr_b16 v[182:183], v116 offset:19392
  s_waitcnt lgkmcnt(10)
  v_mfma_f32_16x16x32_bf16 v[156:159], v[104:107], v[68:71], v[156:159]
  v_mfma_f32_16x16x32_bf16 v[160:163], v[108:111], v[68:71], v[160:163]
  ds_read_b128 v[84:87], v155 offset:16384
  ds_read_b64_tr_b16 v[96:97], v116 offset:20480
  ds_read_b64_tr_b16 v[98:99], v116 offset:20640
  ds_read_b64_tr_b16 v[100:101], v116 offset:20512
  ds_read_b64_tr_b16 v[102:103], v116 offset:20672
  s_waitcnt lgkmcnt(10)
  v_mfma_f32_16x16x32_bf16 v[156:159], v[164:167], v[72:75], v[156:159]
  v_mfma_f32_16x16x32_bf16 v[160:163], v[168:171], v[72:75], v[160:163]
  s_waitcnt vmcnt(1)
  ds_read_b128 v[88:91], v154 offset:18432
  ds_read_b64_tr_b16 v[104:105], v116 offset:21760
  ds_read_b64_tr_b16 v[106:107], v116 offset:21920
  ds_read_b64_tr_b16 v[108:109], v116 offset:21792
  ds_read_b64_tr_b16 v[110:111], v116 offset:21952
  s_waitcnt lgkmcnt(10)
  v_mfma_f32_16x16x32_bf16 v[156:159], v[176:179], v[76:79], v[156:159]
  v_mfma_f32_16x16x32_bf16 v[160:163], v[180:183], v[76:79], v[160:163]
  ds_read_b128 v[92:95], v155 offset:18432
  ds_read_b64_tr_b16 v[164:165], v116 offset:23040
  ds_read_b64_tr_b16 v[166:167], v116 offset:23200
  ds_read_b64_tr_b16 v[168:169], v116 offset:23072
  ds_read_b64_tr_b16 v[170:171], v116 offset:23232
  s_waitcnt lgkmcnt(10)
  v_mfma_f32_16x16x32_bf16 v[156:159], v[96:99], v[80:83], v[156:159]
  v_mfma_f32_16x16x32_bf16 v[160:163], v[100:103], v[80:83], v[160:163]
  ds_read_b64_tr_b16 v[176:177], v116 offset:24320
  ds_read_b64_tr_b16 v[178:179], v116 offset:24480
  ds_read_b64_tr_b16 v[180:181], v116 offset:24352
  ds_read_b64_tr_b16 v[182:183], v116 offset:24512
  s_waitcnt lgkmcnt(9)
  v_mfma_f32_16x16x32_bf16 v[156:159], v[104:107], v[84:87], v[156:159]
  v_mfma_f32_16x16x32_bf16 v[160:163], v[108:111], v[84:87], v[160:163]
  s_waitcnt lgkmcnt(4)
  v_mfma_f32_16x16x32_bf16 v[156:159], v[164:167], v[88:91], v[156:159]
  v_mfma_f32_16x16x32_bf16 v[160:163], v[168:171], v[88:91], v[160:163]
  s_waitcnt lgkmcnt(0)
  v_mfma_f32_16x16x32_bf16 v[156:159], v[176:179], v[92:95], v[156:159]
  v_mfma_f32_16x16x32_bf16 v[160:163], v[180:183], v[92:95], v[160:163]
  s_branch L_kvdone
L_vmm:
  ds_read_b64_tr_b16 v[96:97], v116 offset:0
  ds_read_b64_tr_b16 v[98:99], v116 offset:160
  ds_read_b64_tr_b16 v[100:101], v116 offset:32
  ds_read_b64_tr_b16 v[102:103], v116 offset:192
  ds_read_b64_tr_b16 v[104:105], v116 offset:1280
  ds_read_b64_tr_b16 v[106:107], v116 offset:1440
  ds_read_b64_tr_b16 v[108:109], v116 offset:1312
  ds_read_b64_tr_b16 v[110:111], v116 offset:1472
  ds_read_b64_tr_b16 v[164:165], v116 offset:2560
  ds_read_b64_tr_b16 v[166:167], v116 offset:2720
  ds_read_b64_tr_b16 v[168:169], v116 offset:2592
  ds_read_b64_tr_b16 v[170:171], v116 offset:2752
  s_waitcnt lgkmcnt(8)
  v_mfma_f32_16x16x32_bf16 v[156:159], v[16:19], v[96:99], 0
  v_mfma_f32_16x16x32_bf16 v[160:163], v[16:19], v[100:103], 0
  s_waitcnt vmcnt(8)
  ds_read_b128 v[32:35], v154 offset:4096
  ds_read_b64_tr_b16 v[176:177], v116 offset:3840
  ds_read_b64_tr_b16 v[178:179], v116 offset:4000
  ds_read_b64_tr_b16 v[180:181], v116 offset:3872
  ds_read_b64_tr_b16 v[182:183], v116 offset:4032
  s_waitcnt lgkmcnt(9)
  v_mfma_f32_16x16x32_bf16 v[156:159], v[20:23], v[104:107], v[156:159]
  v_mfma_f32_16x16x32_bf16 v[160:163], v[20:23], v[108:111], v[160:163]
  ds_read_b128 v[36:39], v155 offset:4096
  ds_read_b64_tr_b16 v[96:97], v116 offset:5120
  ds_read_b64_tr_b16 v[98:99], v116 offset:5280
  ds_read_b64_tr_b16 v[100:101], v116 offset:5152
  ds_read_b64_tr_b16 v[102:103], v116 offset:5312
  s_waitcnt lgkmcnt(10)
  v_mfma_f32_16x16x32_bf16 v[156:159], v[24:27], v[164:167], v[156:159]
  v_mfma_f32_16x16x32_bf16 v[160:163], v[24:27], v[168:171], v[160:163]
  s_waitcnt vmcnt(7)
  ds_read_b128 v[40:43], v154 offset:6144
  ds_read_b64_tr_b16 v[104:105], v116 offset:6400
  ds_read_b64_tr_b16 v[106:107], v116 offset:6560
  ds_read_b64_tr_b16 v[108:109], v116 offset:6432
  ds_read_b64_tr_b16 v[110:111], v116 offset:6592
  s_waitcnt lgkmcnt(10)
  v_mfma_f32_16x16x32_bf16 v[156:159], v[28:31], v[176:179], v[156:159]
  v_mfma_f32_16x16x32_bf16 v[160:163], v[28:31], v[180:183], v[160:163]
  ds_read_b128 v[44:47], v155 offset:6144
  ds_read_b64_tr_b16 v[164:165], v116 offset:7680
  ds_read_b64_tr_b16 v[166:167], v116 offset:7840
  ds_read_b64_tr_b16 v[168:169], v116 offset:7712
  ds_read_b64_tr_b16 v[170:171], v116 offset:7872
  s_waitcnt lgkmcnt(10)
  v_mfma_f32_16x16x32_bf16 v[156:159], v[32:35], v[96:99], v[156:159]
  v_mfma_f32_16x16x32_bf16 v[160:163], v[32:35], v[100:103], v[160:163]
  s_waitcnt vmcnt(6)
  ds_read_b128 v[48:51], v154 offset:8192
  ds_read_b64_tr_b16 v[176:177], v116 offset:8960
  ds_read_b64_tr_b16 v[178:179], v116 offset:9120
  ds_read_b64_tr_b16 v[180:181], v116 offset:8992
  ds_read_b64_tr_b16 v[182:183], v116 offset:9152
  s_waitcnt lgkmcnt(10)
  v_mfma_f32_16x16x32_bf16 v[156:159], v[36:39], v[104:107], v[156:159]
  v_mfma_f32_16x16x32_bf16 v[160:163], v[36:39], v[108:111], v[160:163]
  ds_read_b128 v[52:55], v155 offset:8192
  ds_read_b64_tr_b16 v[96:97], v116 offset:10240
  ds_read_b64_tr_b16 v[98:99], v116 offset:10400
  ds_read_b64_tr_b16 v[100:101], v116 offset:10272
  ds_read_b64_tr_b16 v[102:103], v116 offset:10432
  s_waitcnt lgkmcnt(10)
  v_mfma_f32_16x16x32_bf16 v[156:159], v[40:43], v[164:167], v[156:159]
  v_mfma_f32_16x16x32_bf16 v[160:163], v[40:43], v[168:171], v[160:163]
  s_waitcnt vmcnt(5)
  ds_read_b128 v[56:59], v154 offset:10240
  ds_read_b64_tr_b16 v[104:105], v116 offset:11520
  ds_read_b64_tr_b16 v[106:107], v116 offset:11680
  ds_read_b64_tr_b16 v[108:109], v116 offset:11552
  ds_read_b64_tr_b16 v[110:111], v116 offset:11712
  s_waitcnt lgkmcnt(10)
  v_mfma_f32_16x16x32_bf16 v[156:159], v[44:47], v[176:179], v[156:159]
  v_mfma_f32_16x16x32_bf16 v[160:163], v[44:47], v[180:183], v[160:163]
  ds_read_b128 v[60:63], v155 offset:10240
  ds_read_b64_tr_b16 v[164:165], v116 offset:12800
  ds_read_b64_tr_b16 v[166:167], v116 offset:12960
  ds_read_b64_tr_b16 v[168:169], v116 offset:12832
  ds_read_b64_tr_b16 v[170:171], v116 offset:12992
  s_waitcnt lgkmcnt(10)
  v_mfma_f32_16x16x32_bf16 v[156:159], v[48:51], v[96:99], v[156:159]
  v_mfma_f32_16x16x32_bf16 v[160:163], v[48:51], v[100:103], v[160:163]
  s_waitcnt vmcnt(4)
  ds_read_b128 v[64:67], v154 offset:12288
  ds_read_b64_tr_b16 v[176:177], v116 offset:14080
  ds_read_b64_tr_b16 v[178:179], v116 offset:14240
  ds_read_b64_tr_b16 v[180:181], v116 offset:14112
  ds_read_b64_tr_b16 v[182:183], v116 offset:14272
  s_waitcnt lgkmcnt(10)
  v_mfma_f32_16x16x32_bf16 v[156:159], v[52:55], v[104:107], v[156:159]
  v_mfma_f32_16x16x32_bf16 v[160:163], v[52:55], v[108:111], v[160:163]
  ds_read_b128 v[68:71], v155 offset:12288
  ds_read_b64_tr_b16 v[96:97], v116 offset:15360
  ds_read_b64_tr_b16 v[98:99], v116 offset:15520
  ds_read_b64_tr_b16 v[100:101], v116 offset:15392
  ds_read_b64_tr_b16 v[102:103], v116 offset:15552
  s_waitcnt lgkmcnt(10)
  v_mfma_f32_16x16x32_bf16 v[156:159], v[56:59], v[164:167], v[156:159]
  v_mfma_f32_16x16x32_bf16 v[160:163], v[56:59], v[168:171], v[160:163]
  s_waitcnt vmcnt(3)
  ds_read_b128 v[72:75], v154 offset:14336
  ds_read_b64_tr_b16 v[104:105], v116 offset:16640
  ds_read_b64_tr_b16 v[106:107], v116 offset:16800
  ds_read_b64_tr_b16 v[108:109], v116 offset:16672
  ds_read_b64_tr_b16 v[110:111], v116 offset:16832
  s_waitcnt lgkmcnt(10)
  v_mfma_f32_16x16x32_bf16 v[156:159], v[60:63], v[176:179], v[156:159]
  v_mfma_f32_16x16x32_bf16 v[160:163], v[60:63], v[180:183], v[160:163]
  ds_read_b128 v[76:79], v155 offset:14336
  ds_read_b64_tr_b16 v[164:165], v116 offset:17920
  ds_read_b64_tr_b16 v[166:167], v116 offset:18080
  ds_read_b64_tr_b16 v[168:169], v116 offset:17952
  ds_read_b64_tr_b16 v[170:171], v116 offset:18112
  s_waitcnt lgkmcnt(10)
  v_mfma_f32_16x16x32_bf16 v[156:159], v[64:67], v[96:99], v[156:159]
  v_mfma_f32_16x16x32_bf16 v[160:163], v[64:67], v[100:103], v[160:163]
  s_waitcnt vmcnt(2)
  ds_read_b128 v[80:83], v154 offset:16384
  ds_read_b64_tr_b16 v[176:177], v116 offset:19200
  ds_read_b64_tr_b16 v[178:179], v116 offset:19360
  ds_read_b64_tr_b16 v[180:181], v116 offset:19232
  ds_read_b64_tr_b16 v[182:183], v116 offset:19392
  s_waitcnt lgkmcnt(10)
  v_mfma_f32_16x16x32_bf16 v[156:159], v[68:71], v[104:107], v[156:159]
  v_mfma_f32_16x16x32_bf16 v[160:163], v[68:71], v[108:111], v[160:163]
  ds_read_b128 v[84:87], v155 offset:16384
  ds_read_b64_tr_b16 v[96:97], v116 offset:20480
  ds_read_b64_tr_b16 v[98:99], v116 offset:20640
  ds_read_b64_tr_b16 v[100:101], v116 offset:20512
  ds_read_b64_tr_b16 v[102:103], v116 offset:20672
  s_waitcnt lgkmcnt(10)
  v_mfma_f32_16x16x32_bf16 v[156:159], v[72:75], v[164:167], v[156:159]
  v_mfma_f32_16x16x32_bf16 v[160:163], v[72:75], v[168:171], v[160:163]
  s_waitcnt vmcnt(1)
  ds_read_b128 v[88:91], v154 offset:18432
  ds_read_b64_tr_b16 v[104:105], v116 offset:21760
  ds_read_b64_tr_b16 v[106:107], v116 offset:21920
  ds_read_b64_tr_b16 v[108:109], v116 offset:21792
  ds_read_b64_tr_b16 v[110:111], v116 offset:21952
  s_waitcnt lgkmcnt(10)
  v_mfma_f32_16x16x32_bf16 v[156:159], v[76:79], v[176:179], v[156:159]
  v_mfma_f32_16x16x32_bf16 v[160:163], v[76:79], v[180:183], v[160:163]
  ds_read_b128 v[92:95], v155 offset:18432
  ds_read_b64_tr_b16 v[164:165], v116 offset:23040
  ds_read_b64_tr_b16 v[166:167], v116 offset:23200
  ds_read_b64_tr_b16 v[168:169], v116 offset:23072
  ds_read_b64_tr_b16 v[170:171], v116 offset:23232
  s_waitcnt lgkmcnt(10)
  v_mfma_f32_16x16x32_bf16 v[156:159], v[80:83], v[96:99], v[156:159]
  v_mfma_f32_16x16x32_bf16 v[160:163], v[80:83], v[100:103], v[160:163]
  ds_read_b64_tr_b16 v[176:177], v116 offset:24320
  ds_read_b64_tr_b16 v[178:179], v116 offset:24480
  ds_read_b64_tr_b16 v[180:181], v116 offset:24352
  ds_read_b64_tr_b16 v[182:183], v116 offset:24512
  s_waitcnt lgkmcnt(9)
  v_mfma_f32_16x16x32_bf16 v[156:159], v[84:87], v[104:107], v[156:159]
  v_mfma_f32_16x16x32_bf16 v[160:163], v[84:87], v[108:111], v[160:163]
  s_waitcnt lgkmcnt(4)
  v_mfma_f32_16x16x32_bf16 v[156:159], v[88:91], v[164:167], v[156:159]
  v_mfma_f32_16x16x32_bf16 v[160:163], v[88:91], v[168:171], v[160:163]
  s_waitcnt lgkmcnt(0)
  v_mfma_f32_16x16x32_bf16 v[156:159], v[92:95], v[176:179], v[156:159]
  v_mfma_f32_16x16x32_bf16 v[160:163], v[92:95], v[180:183], v[160:163]
L_kvdone:
  s_nop 6
  v_pk_mul_f32 v[156:157], v[156:157], s[4:5]
  v_pk_mul_f32 v[158:159], v[158:159], s[4:5]
  v_pk_mul_f32 v[160:161], v[160:161], s[4:5]
  v_pk_mul_f32 v[162:163], v[162:163], s[4:5]
  v_cvt_pk_bf16_f32 v184, v156, v157
  v_cvt_pk_bf16_f32 v185, v158, v159
  v_cvt_pk_bf16_f32 v186, v160, v161
  v_cvt_pk_bf16_f32 v187, v162, v163
  buffer_store_dwordx2 v[184:185], v114, s[40:43], s52 offen
  v_cndmask_b32 v186, v112, v186, s[8:9]
  v_cndmask_b32 v187, v113, v187, s[8:9]
  s_mov_b64 exec, s[10:11]
  buffer_store_dwordx2 v[186:187], v115, s[40:43], s52 offen
  buffer_store_dwordx2 v[186:187], v115, s[40:43], s6 offen sc1
  s_mov_b64 exec, -1
  buffer_store_dwordx2 v[184:185], v114, s[40:43], s6 offen sc1
  s_mov_b64 exec, 1
  s_or_b32 s55, s62, s16
  v_mov_b32 v3, s55
  s_waitcnt vmcnt(2)
  buffer_store_dword v3, off, s[40:43], s53
  s_waitcnt vmcnt(1)
  buffer_store_dword v3, off, s[40:43], s7 sc1
  s_mov_b64 exec, -1
  s_setprio 0
.p2align 5
L_setup:
  v_lshrrev_b32 v1, 3, v0
  v_and_b32 v2, 7, v0
  v_and_b32 v3, 6, v1
  v_xor_b32 v2, v2, v3
  v_mul_u32_u24 v153, 1280, v1
  v_lshl_add_u32 v153, v2, 4, v153
  s_lshl_b32 s26, s20, 2
  s_add_u32 s26, s26, s23
  s_mul_i32 s52, s26, 20480
  s_mov_b32 s57, s52
  s_mul_i32 s56, s48, 8192
  s_add_u32 s56, s56, 32768
  s_cmp_eq_u32 s48, 0
  s_cselect_b32 s56, 128512, s56
  s_mov_b32 s30, 2621440
  s_mov_b32 s31, 0x20000
  s_mov_b32 s34, 819200
  s_mov_b32 s35, 0x20000
  s_mov_b32 s42, 4194304
  s_mov_b32 s43, 0x20000
  s_mov_b32 s46, 2621440
  s_mov_b32 s47, 0x20000
  s_mov_b32 s49, 0
  v_lshlrev_b32 v6, 4, v0
  v_and_b32 v13, 15, v0
  v_lshrrev_b32 v14, 4, v0
  v_lshrrev_b32 v1, 3, v13
  v_lshlrev_b32 v1, 10, v1
  v_and_b32 v2, 7, v13
  v_lshl_add_u32 v1, v2, 7, v1
  v_and_b32 v2, 6, v13
  v_xor_b32 v2, v2, v14
  v_lshl_add_u32 v1, v2, 4, v1
  v_add_u32 v154, s56, v1
  v_xor_b32 v155, 64, v154
  s_mov_b32 s60, 0
  s_mov_b32 s59, 0
  s_mul_i32 s50, s22, 3072
  v_mov_b32 v5, 0xdddddddd
  s_mul_i32 s25, s21, 160
  s_movk_i32 s26, 1280
  s_movk_i32 s27, 176
  s_mul_i32 s53, s23, 3072
  s_add_u32 s53, s53, 102400
  s_lshl_b32 s54, s24, 7
  v_add_u32 v1, 0, v0
  v_mul_u32_u24 v2, 6554, v1
  v_lshrrev_b32 v2, 16, v2
  v_mul_u32_u24 v3, 10, v2
  v_sub_u32 v1, v1, v3
  v_lshl_add_u32 v3, v1, 4, s53
  v_mad_u32_u24 v244, v2, s27, v3
  v_lshl_add_u32 v1, v1, 4, s25
  v_mad_u32_u24 v3, v2, s26, v1
  v_add_u32 v247, s52, v3
  v_lshrrev_b32 v3, 1, v2
  v_and_b32 v3, 4, v3
  v_xor_b32 v2, v2, v3
  v_mad_u32_u24 v16, v2, s26, v1
  v_and_b32 v3, 3, v2
  v_lshrrev_b32 v4, 4, v2
  v_mad_u32_u24 v3, v4, 20, v3
  v_bfe_u32 v4, v2, 3, 1
  v_lshl_add_u32 v3, v4, 2, v3
  v_bfe_u32 v4, v2, 2, 1
  v_lshl_add_u32 v3, v4, 3, v3
  v_mad_u32_u24 v136, v3, s26, v1
  v_add_u32 v1, 64, v0
  v_mul_u32_u24 v2, 6554, v1
  v_lshrrev_b32 v2, 16, v2
  v_mul_u32_u24 v3, 10, v2
  v_sub_u32 v1, v1, v3
  v_lshl_add_u32 v3, v1, 4, s53
  v_mad_u32_u24 v245, v2, s27, v3
  v_lshl_add_u32 v1, v1, 4, s25
  v_mad_u32_u24 v3, v2, s26, v1
  v_add_u32 v248, s52, v3
  v_lshrrev_b32 v3, 1, v2
  v_and_b32 v3, 4, v3
  v_xor_b32 v2, v2, v3
  v_subrev_u32 v1, 1024, v1
  v_mad_u32_u24 v17, v2, s26, v1
  v_and_b32 v3, 3, v2
  v_lshrrev_b32 v4, 4, v2
  v_mad_u32_u24 v3, v4, 20, v3
  v_bfe_u32 v4, v2, 3, 1
  v_lshl_add_u32 v3, v4, 2, v3
  v_bfe_u32 v4, v2, 2, 1
  v_lshl_add_u32 v3, v4, 3, v3
  v_mad_u32_u24 v137, v3, s26, v1
  v_add_u32 v1, 128, v0
  v_mul_u32_u24 v2, 6554, v1
  v_lshrrev_b32 v2, 16, v2
  v_mul_u32_u24 v3, 10, v2
  v_sub_u32 v1, v1, v3
  v_lshl_add_u32 v3, v1, 4, s53
  v_mad_u32_u24 v246, v2, s27, v3
  v_lshl_add_u32 v1, v1, 4, s25
  v_mad_u32_u24 v3, v2, s26, v1
  v_add_u32 v249, s52, v3
  v_lshrrev_b32 v3, 1, v2
  v_and_b32 v3, 4, v3
  v_xor_b32 v2, v2, v3
  v_subrev_u32 v1, 2048, v1
  v_mad_u32_u24 v18, v2, s26, v1
  v_and_b32 v3, 3, v2
  v_lshrrev_b32 v4, 4, v2
  v_mad_u32_u24 v3, v4, 20, v3
  v_bfe_u32 v4, v2, 3, 1
  v_lshl_add_u32 v3, v4, 2, v3
  v_bfe_u32 v4, v2, 2, 1
  v_lshl_add_u32 v3, v4, 3, v3
  v_mad_u32_u24 v138, v3, s26, v1
  v_add_u32 v1, 192, v0
  v_mul_u32_u24 v2, 6554, v1
  v_lshrrev_b32 v2, 16, v2
  v_mul_u32_u24 v3, 10, v2
  v_sub_u32 v1, v1, v3
  v_lshl_add_u32 v1, v1, 4, s25
  v_lshrrev_b32 v3, 1, v2
  v_and_b32 v3, 4, v3
  v_xor_b32 v2, v2, v3
  v_subrev_u32 v1, 3072, v1
  v_mad_u32_u24 v19, v2, s26, v1
  v_and_b32 v3, 3, v2
  v_lshrrev_b32 v4, 4, v2
  v_mad_u32_u24 v3, v4, 20, v3
  v_bfe_u32 v4, v2, 3, 1
  v_lshl_add_u32 v3, v4, 2, v3
  v_bfe_u32 v4, v2, 2, 1
  v_lshl_add_u32 v3, v4, 3, v3
  v_mad_u32_u24 v139, v3, s26, v1
  v_add_u32 v1, 256, v0
  v_mul_u32_u24 v2, 6554, v1
  v_lshrrev_b32 v2, 16, v2
  v_mul_u32_u24 v3, 10, v2
  v_sub_u32 v1, v1, v3
  v_lshl_add_u32 v1, v1, 4, s25
  v_lshrrev_b32 v3, 1, v2
  v_and_b32 v3, 4, v3
  v_xor_b32 v2, v2, v3
  v_mad_u32_u24 v20, v2, s26, v1
  v_and_b32 v3, 3, v2
  v_lshrrev_b32 v4, 4, v2
  v_mad_u32_u24 v3, v4, 20, v3
  v_bfe_u32 v4, v2, 3, 1
  v_lshl_add_u32 v3, v4, 2, v3
  v_bfe_u32 v4, v2, 2, 1
  v_lshl_add_u32 v3, v4, 3, v3
  v_mad_u32_u24 v140, v3, s26, v1
  v_add_u32 v1, s54, v0
  v_mul_u32_u24 v2, 6554, v1
  v_lshrrev_b32 v2, 16, v2
  v_mul_u32_u24 v3, 10, v2
  v_sub_u32 v1, v1, v3
  s_add_u32 s54, s54, 64
  v_lshl_add_u32 v1, v1, 4, s25
  v_lshrrev_b32 v3, 1, v2
  v_and_b32 v3, 4, v3
  v_xor_b32 v2, v2, v3
  v_and_b32 v3, 3, v2
  v_lshrrev_b32 v4, 2, v2
  v_mad_u32_u24 v4, v4, 20, v3
  v_lshrrev_b32 v3, 3, v2
  v_mad_u32_u24 v4, v3, 40, v4
  v_mad_u32_u24 v4, v4, s26, v1
  v_add_u32 v141, 20480, v4
  v_add_u32 v1, s54, v0
  v_mul_u32_u24 v2, 6554, v1
  v_lshrrev_b32 v2, 16, v2
  v_mul_u32_u24 v3, 10, v2
  v_sub_u32 v1, v1, v3
  s_add_u32 s54, s54, 64
  v_lshl_add_u32 v1, v1, 4, s25
  v_lshrrev_b32 v3, 1, v2
  v_and_b32 v3, 4, v3
  v_xor_b32 v2, v2, v3
  v_and_b32 v3, 3, v2
  v_lshrrev_b32 v4, 2, v2
  v_mad_u32_u24 v4, v4, 20, v3
  v_lshrrev_b32 v3, 3, v2
  v_mad_u32_u24 v4, v3, 40, v4
  v_mad_u32_u24 v4, v4, s26, v1
  v_add_u32 v142, 19456, v4
  v_add_u32 v1, s54, v0
  v_mul_u32_u24 v2, 6554, v1
  v_lshrrev_b32 v2, 16, v2
  v_mul_u32_u24 v3, 10, v2
  v_sub_u32 v1, v1, v3
  s_add_u32 s54, s54, 64
  v_lshl_add_u32 v1, v1, 4, s25
  v_lshrrev_b32 v3, 1, v2
  v_and_b32 v3, 4, v3
  v_xor_b32 v2, v2, v3
  v_and_b32 v3, 3, v2
  v_lshrrev_b32 v4, 2, v2
  v_mad_u32_u24 v4, v4, 20, v3
  v_lshrrev_b32 v3, 3, v2
  v_mad_u32_u24 v4, v3, 40, v4
  v_mad_u32_u24 v4, v4, s26, v1
  v_add_u32 v143, 18432, v4
  v_mul_u32_u24 v1, 40, v14
  v_mad_u32_u24 v1, v13, s27, v1
  v_add_u32 v243, s53, v1
  s_cmp_eq_u32 s24, 0
  s_cbranch_scc0 L_mids
  s_waitcnt lgkmcnt(0)
  s_mov_b32 s28, s4
  s_and_b32 s29, s5, 0xffff
  s_getpc_b64 s[8:9]
L_dpc0:
  s_add_u32 s8, s8, L_tbl-L_dpc0
  s_addc_u32 s9, s9, 0
  v_mov_b32 v7, 0
  v_add_u32 v8, 9216, v153
  s_lshl2_add_u32 s27, s23, 163376
  s_mov_b32 s55, s56
  s_mul_i32 s11, s48, 0
  s_add_u32 s11, s11, 24576
  s_mul_i32 s39, s48, -4096
  s_add_u32 s39, s39, 28672
  s_cmp_eq_u32 s48, 0
  s_cselect_b32 s11, 8192, s11
  s_cselect_b32 s39, 8192, s39
  s_cbranch_scc1 L_nu0
  s_mov_b32 m0, s56
  s_barrier
  buffer_load_dwordx4 v153, s[28:31], s57 offen lds
  buffer_load_dwordx4 v8, s[28:31], s57 offen offset:1024 lds
  s_add_u32 m0, m0, 2048
  s_add_u32 s57, s57, 128
  buffer_load_dwordx4 v153, s[28:31], s57 offen lds
  buffer_load_dwordx4 v8, s[28:31], s57 offen offset:1024 lds
  s_add_u32 m0, m0, 2048
  s_add_u32 s57, s57, 128
  buffer_load_dwordx4 v153, s[28:31], s57 offen lds
  buffer_load_dwordx4 v8, s[28:31], s57 offen offset:1024 lds
  s_add_u32 m0, m0, 2048
  s_add_u32 s57, s57, 128
  buffer_load_dwordx4 v153, s[28:31], s57 offen lds
  buffer_load_dwordx4 v8, s[28:31], s57 offen offset:1024 lds
  s_sub_u32 m0, s27, 4
  s_mov_b64 exec, 1
  global_load_lds_dword v7, s[8:9] offset:4
  s_mov_b64 exec, -1
  s_add_u32 s55, s55, s11
  s_mov_b32 m0, s55
  s_add_u32 s57, s57, 128
  buffer_load_dwordx4 v153, s[28:31], s57 offen lds
  buffer_load_dwordx4 v8, s[28:31], s57 offen offset:1024 lds
  s_add_u32 m0, m0, 2048
  s_add_u32 s57, s57, 128
  buffer_load_dwordx4 v153, s[28:31], s57 offen lds
  buffer_load_dwordx4 v8, s[28:31], s57 offen offset:1024 lds
  s_add_u32 m0, m0, 2048
  s_add_u32 s57, s57, 128
  buffer_load_dwordx4 v153, s[28:31], s57 offen lds
  buffer_load_dwordx4 v8, s[28:31], s57 offen offset:1024 lds
  s_add_u32 m0, m0, 2048
  s_add_u32 s57, s57, 128
  buffer_load_dwordx4 v153, s[28:31], s57 offen lds
  buffer_load_dwordx4 v8, s[28:31], s57 offen offset:1024 lds
  s_sub_u32 m0, s27, 8
  s_mov_b64 exec, 1
  global_load_lds_dword v7, s[8:9] offset:8
  s_mov_b64 exec, -1
  s_add_u32 s55, s55, s39
  s_mov_b32 m0, s55
  s_add_u32 s57, s57, 128
  buffer_load_dwordx4 v153, s[28:31], s57 offen lds
  buffer_load_dwordx4 v8, s[28:31], s57 offen offset:1024 lds
  s_add_u32 m0, m0, 2048
  s_add_u32 s57, s57, 128
  buffer_load_dwordx4 v153, s[28:31], s57 offen lds
  buffer_load_dwordx4 v8, s[28:31], s57 offen offset:1024 lds
  s_sub_u32 m0, s27, 12
  s_mov_b64 exec, 1
  global_load_lds_dword v7, s[8:9] offset:12
  s_mov_b64 exec, -1
L_midd:
  s_mul_i32 s25, s23, 5120
  s_add_u32 s25, s25, 128512
  v_add_u32 v238, s25, v6
  v_bfe_u32 v1, v0, 2, 2
  v_and_b32 v2, 3, v0
  v_lshl_add_u32 v3, v14, 3, v1
  v_and_b32 v4, 1, v14
  v_lshl_add_u32 v4, v4, 2, v3
  v_xor_b32 v7, 4, v4
  v_mul_u32_u24 v8, 40, v2
  s_mul_i32 s26, s24, 51200
  v_add_u32 v8, s26, v8
  s_movk_i32 s27, 160
  v_mad_u32_u24 v239, v4, s27, v8
  v_mad_u32_u24 v240, v7, s27, v8
  v_mov_b32 v152, 163328
  v_xor_b32 v1, s3, v0
  v_and_b32 v1, 7, v1
  v_lshl_add_u32 v1, v1, 3, s22
  v_lshlrev_b32 v145, 7, v1
  v_and_b32 v1, 7, v0
  s_lshl_b32 s26, s20, 7
  v_lshl_add_u32 v146, v1, 2, s26
  v_lshlrev_b32 v147, 3, v0
  s_mul_i32 s25, s24, 12288
  s_add_u32 s25, s25, 102400
  v_add_u32 v232, s25, v6
  s_add_u32 s26, s25, 1024
  v_add_u32 v233, s26, v147
  v_and_b32 v7, 31, v0
  v_lshrrev_b32 v8, 5, v0
  v_mul_u32_u24 v3, 24, v8
  v_min_u32 v10, 23, v7
  v_add_u32 v3, v3, v10
  s_add_u32 s26, s25, 1536
  v_lshl_add_u32 v234, v3, 4, s26
  s_and_b32 s25, s23, 1
  s_mul_i32 s25, s25, 2560
  s_lshr_b32 s26, s23, 1
  s_mul_i32 s26, s26, 1280
  s_add_u32 s25, s25, s26
  s_add_u32 s25, s25, 153088
  s_mul_i32 s26, s24, 5120
  s_sub_u32 s27, 5120, s26
  s_add_u32 s26, s25, s26
  s_add_u32 s27, s25, s27
  v_add_u32 v250, s27, v6
  v_add_u32 v251, s26, v6
  v_lshl_add_u32 v252, v7, 3, s27
  v_lshl_add_u32 v253, v7, 3, s26
  s_lshr_b32 s25, s23, 1
  s_mul_i32 s25, s25, 1280
  s_add_u32 s25, s25, 153088
  s_and_b32 s26, s23, 1
  s_lshl_b32 s26, s26, 4
  v_add_u32 v1, s26, v13
  v_mul_u32_u24 v2, 2560, v14
  v_add_u32 v2, s25, v2
  v_lshl_add_u32 v254, v1, 4, v2
  v_lshl_add_u32 v255, v1, 3, v2
  v_lshrrev_b32 v7, 1, v14
  v_and_b32 v8, 1, v14
  v_lshl_add_u32 v9, v8, 5, v1
  v_lshlrev_b32 v9, 4, v9
  v_lshl_add_u32 v236, v7, 10, v9
  v_mul_u32_u24 v3, 5120, v7
  v_lshl_add_u32 v3, v8, 9, v3
  v_lshl_add_u32 v3, v1, 3, v3
  v_add_u32 v237, 4096, v3
  s_add_u32 s25, s50, 102400
  v_add_u32 v241, s25, v6
  s_xor_b32 s25, s22, 4
  s_mul_i32 s25, s25, 3072
  s_add_u32 s25, s25, 102400
  v_add_u32 v242, s25, v6
  v_mov_b64 v[196:197], 0
  v_mov_b64 v[198:199], 0
  v_mov_b64 v[200:201], 0
  v_mov_b64 v[202:203], 0
  v_mov_b64 v[204:205], 0
  v_mov_b64 v[206:207], 0
  v_mov_b64 v[208:209], 0
  v_mov_b64 v[210:211], 0
  v_mov_b64 v[212:213], 0
  v_mov_b64 v[214:215], 0
  v_mov_b64 v[216:217], 0
  v_mov_b64 v[218:219], 0
  v_mov_b64 v[220:221], 0
  v_mov_b64 v[222:223], 0
  v_mov_b64 v[224:225], 0
  v_mov_b64 v[226:227], 0
  v_mov_b64 v[228:229], 0
  v_mov_b64 v[230:231], 0
  s_waitcnt lgkmcnt(0)
  s_mov_b32 s40, s18
  s_and_b32 s41, s19, 0xffff
  s_mov_b32 s44, s14
  s_and_b32 s45, s15, 0xffff
  s_lshr_b32 s17, s2, 3
  s_getreg_b32 s16, hwreg(HW_REG_XCC_ID, 0, 4)
  s_cmp_eq_u32 s24, 0
  s_cbranch_scc0 L_hlp2
  s_load_dword s62, s[18:19], 294912
  s_and_b32 s25, s23, 1
  s_lshl_b32 s26, s25, 4
  v_add_u32 v13, s26, v239
  v_add_u32 v14, s26, v240
  v_mov_b32 v3, v239
  v_mov_b32 v4, v240
  s_lshl_b32 s26, s25, 9
  v_add_u32 v15, s26, v254
  s_and_b32 s26, s23, 2
  s_lshl2_add_u32 s26, s26, 163376
  v_mov_b32 v1, s26
  s_lshl1_add_u32 s26, s25, s48
  s_add_u32 s26, s26, 1
  s_and_b32 s26, s26, 3
  s_mul_i32 s27, s26, 8192
  s_add_u32 s27, s27, 32768
  s_mul_i32 s10, s26, 0
  s_add_u32 s10, s10, 24576
  s_mul_i32 s38, s26, -4096
  s_add_u32 s38, s38, 28672
  s_cmp_eq_u32 s26, 0
  s_cselect_b32 s10, 8192, s10
  s_cselect_b32 s38, 8192, s38
  s_cselect_b32 s27, 128512, s27
  s_sub_u32 s27, s27, s56
  v_add_u32 v11, s27, v154
  v_add_u32 v12, s27, v155
  s_waitcnt lgkmcnt(0)
  s_add_u32 s62, s62, 0x9e3779b0
  s_andn2_b32 s62, s62, 15
  s_mov_b32 s63, s62
L_gemm:
  s_setprio 0
  ds_read_b64 v[8:9], v1
  s_waitcnt lgkmcnt(0)
  v_min_u32 v9, v8, v9
  s_nop 0
  v_readfirstlane_b32 s58, v9
  s_cmp_ge_u32 s58, 3212836865
  s_cbranch_scc0 S_n1
L_n1:
  ds_read_b128 v[16:19], v154 offset:0
  ds_read_b128 v[20:23], v11 offset:0
  ds_read_b128 v[24:27], v155 offset:0
  ds_read_b128 v[28:31], v12 offset:0
  ds_read_b128 v[32:35], v154 offset:2048
  ds_read_b128 v[36:39], v11 offset:2048
  ds_read_b128 v[40:43], v155 offset:2048
  ds_read_b128 v[44:47], v12 offset:2048
  ds_read_b128 v[48:51], v154 offset:4096
  ds_read_b128 v[52:55], v11 offset:4096
  ds_read_b128 v[56:59], v155 offset:4096
  ds_read_b128 v[60:63], v12 offset:4096
  ds_read_b128 v[64:67], v154 offset:6144
  ds_read_b128 v[68:71], v11 offset:6144
  ds_read_b128 v[72:75], v155 offset:6144
  ds_read_b128 v[76:79], v12 offset:6144
  s_mov_b64 exec, 1
  ds_add_u32 v152, v5 offset:32
  s_mov_b64 exec, -1
  ds_read_b32 v2, v152 offset:0
  s_waitcnt lgkmcnt(0)
  v_readfirstlane_b32 s51, v2
  s_cmp_ge_u32 s51, 3212836865
  s_cbranch_scc0 S_n2
L_n2:
  ds_read_b64_tr_b16 v[96:97], v13 offset:0
  ds_read_b64_tr_b16 v[98:99], v14 offset:0
  ds_read_b64_tr_b16 v[100:101], v13 offset:8
  ds_read_b64_tr_b16 v[102:103], v14 offset:8
  ds_read_b64_tr_b16 v[104:105], v3 offset:32
  ds_read_b64_tr_b16 v[106:107], v4 offset:32
  ds_read_b64 v[8:9], v1
  s_cmp_ge_u32 s51, 3212836866
  s_cbranch_scc0 S_n3
L_n3:
  ds_read_b64_tr_b16 v[156:157], v13 offset:5120
  ds_read_b64_tr_b16 v[158:159], v14 offset:5120
  ds_read_b64_tr_b16 v[160:161], v13 offset:5128
  ds_read_b64_tr_b16 v[162:163], v14 offset:5128
  ds_read_b64_tr_b16 v[164:165], v3 offset:5152
  ds_read_b64_tr_b16 v[166:167], v4 offset:5152
  ds_read_b32 v2, v152 offset:4
  s_waitcnt lgkmcnt(12)
  v_mfma_f32_16x16x32_bf16 v[116:119], v[96:99], v[16:19], 0
  v_mfma_f32_16x16x32_bf16 v[124:127], v[96:99], v[20:23], 0
  s_waitcnt lgkmcnt(0)
  v_readfirstlane_b32 s51, v2
  v_mfma_f32_16x16x32_bf16 v[120:123], v[100:103], v[16:19], 0
  v_add_u32 v154, s11, v154
  v_add_u32 v155, s11, v155
  v_add_u32 v11, s10, v11
  v_add_u32 v12, s10, v12
  v_min_u32 v9, v8, v9
  s_nop 0
  v_readfirstlane_b32 s58, v9
  s_cmp_ge_u32 s58, 3212836866
  s_cbranch_scc0 S_n4
L_n4:
  ds_read_b128 v[80:83], v154 offset:0
  ds_read_b128 v[84:87], v11 offset:0
  ds_read_b128 v[88:91], v155 offset:0
  ds_read_b128 v[92:95], v12 offset:0
  s_cmp_ge_u32 s51, 3212836867
  s_cbranch_scc0 S_n5
L_n5:
  ds_read_b64_tr_b16 v[176:177], v13 offset:10240
  ds_read_b64_tr_b16 v[178:179], v14 offset:10240
  ds_read_b32 v2, v152 offset:4
  v_mfma_f32_16x16x32_bf16 v[128:131], v[100:103], v[20:23], 0
  ds_read_b128 v[196:199], v154 offset:2048
  ds_read_b128 v[200:203], v11 offset:2048
  ds_read_b128 v[204:207], v155 offset:2048
  ds_read_b128 v[208:211], v12 offset:2048
  ds_read_b64_tr_b16 v[180:181], v13 offset:10248
  ds_read_b64_tr_b16 v[182:183], v14 offset:10248
  v_mfma_f32_16x16x32_bf16 v[132:135], v[104:107], v[16:19], 0
  ds_read_b128 v[212:215], v154 offset:4096
  ds_read_b128 v[216:219], v11 offset:4096
  ds_read_b128 v[220:223], v155 offset:4096
  ds_read_b128 v[224:227], v12 offset:4096
  ds_read_b64_tr_b16 v[184:185], v3 offset:10272
  ds_read_b64_tr_b16 v[186:187], v4 offset:10272
  v_mfma_f32_16x16x32_bf16 v[116:119], v[156:159], v[24:27], v[116:119]
  ds_read_b128 v[108:111], v154 offset:6144
  ds_read_b128 v[112:115], v11 offset:6144
  ds_read_b128 v[168:171], v155 offset:6144
  ds_read_b128 v[172:175], v12 offset:6144
  v_mfma_f32_16x16x32_bf16 v[124:127], v[156:159], v[28:31], v[124:127]
  s_mov_b64 exec, 1
  ds_add_u32 v152, v5 offset:36
  s_mov_b64 exec, -1
  s_waitcnt lgkmcnt(14)
  v_readfirstlane_b32 s51, v2
  v_mfma_f32_16x16x32_bf16 v[120:123], v[160:163], v[24:27], v[120:123]
  s_cmp_ge_u32 s51, 3212836868
  s_cbranch_scc0 S_n6
L_n6:
  ds_read_b64_tr_b16 v[96:97], v13 offset:15360
  ds_read_b64_tr_b16 v[98:99], v14 offset:15360
  ds_read_b32 v2, v152 offset:4
  v_mfma_f32_16x16x32_bf16 v[128:131], v[160:163], v[28:31], v[128:131]
  ds_read_b64_tr_b16 v[100:101], v13 offset:15368
  ds_read_b64_tr_b16 v[102:103], v14 offset:15368
  v_mfma_f32_16x16x32_bf16 v[132:135], v[164:167], v[24:27], v[132:135]
  ds_read_b64_tr_b16 v[104:105], v3 offset:15392
  ds_read_b64_tr_b16 v[106:107], v4 offset:15392
  s_waitcnt lgkmcnt(12)
  v_mfma_f32_16x16x32_bf16 v[116:119], v[176:179], v[32:35], v[116:119]
  v_mfma_f32_16x16x32_bf16 v[124:127], v[176:179], v[36:39], v[124:127]
  s_waitcnt lgkmcnt(4)
  v_readfirstlane_b32 s51, v2
  v_mfma_f32_16x16x32_bf16 v[120:123], v[180:183], v[32:35], v[120:123]
  ds_read_b64 v[8:9], v1
  s_cmp_ge_u32 s51, 3212836869
  s_cbranch_scc0 S_n7
L_n7:
  ds_read_b64_tr_b16 v[156:157], v13 offset:20480
  ds_read_b64_tr_b16 v[158:159], v14 offset:20480
  ds_read_b32 v2, v152 offset:4
  v_mfma_f32_16x16x32_bf16 v[128:131], v[180:183], v[36:39], v[128:131]
  ds_read_b64_tr_b16 v[160:161], v13 offset:20488
  ds_read_b64_tr_b16 v[162:163], v14 offset:20488
  v_mfma_f32_16x16x32_bf16 v[132:135], v[184:187], v[32:35], v[132:135]
  ds_read_b64_tr_b16 v[164:165], v3 offset:20512
  ds_read_b64_tr_b16 v[166:167], v4 offset:20512
  s_waitcnt lgkmcnt(8)
  v_mfma_f32_16x16x32_bf16 v[116:119], v[96:99], v[40:43], v[116:119]
  v_add_u32 v154, s39, v154
  v_add_u32 v155, s39, v155
  v_add_u32 v11, s38, v11
  v_add_u32 v12, s38, v12
  s_waitcnt lgkmcnt(7)
  v_min_u32 v9, v8, v9
  s_nop 0
  v_readfirstlane_b32 s58, v9
  s_cmp_ge_u32 s58, 3212836867
  s_cbranch_scc0 S_n8
L_n8:
  ds_read_b128 v[16:19], v154 offset:0
  ds_read_b128 v[20:23], v11 offset:0
  v_mfma_f32_16x16x32_bf16 v[124:127], v[96:99], v[44:47], v[124:127]
  ds_read_b128 v[24:27], v155 offset:0
  ds_read_b128 v[28:31], v12 offset:0
  s_waitcnt lgkmcnt(8)
  v_readfirstlane_b32 s51, v2
  v_mfma_f32_16x16x32_bf16 v[120:123], v[100:103], v[40:43], v[120:123]
  ds_read_b128 v[32:35], v154 offset:2048
  ds_read_b128 v[36:39], v11 offset:2048
  s_cmp_ge_u32 s51, 3212836870
  s_cbranch_scc0 S_n9
L_n9:
  ds_read_b64_tr_b16 v[176:177], v13 offset:25600
  ds_read_b64_tr_b16 v[178:179], v14 offset:25600
  ds_read_b32 v2, v152 offset:4
  v_mfma_f32_16x16x32_bf16 v[128:131], v[100:103], v[44:47], v[128:131]
  ds_read_b64_tr_b16 v[180:181], v13 offset:25608
  ds_read_b64_tr_b16 v[182:183], v14 offset:25608
  v_mfma_f32_16x16x32_bf16 v[132:135], v[104:107], v[40:43], v[132:135]
  ds_read_b128 v[40:43], v155 offset:2048
  ds_read_b128 v[44:47], v12 offset:2048
  s_mov_b64 exec, 1
  ds_add_u32 v152, v5 offset:40
  s_mov_b64 exec, -1
  ds_read_b64_tr_b16 v[184:185], v3 offset:25632
  ds_read_b64_tr_b16 v[186:187], v4 offset:25632
  s_waitcnt lgkmcnt(14)
  v_mfma_f32_16x16x32_bf16 v[116:119], v[156:159], v[48:51], v[116:119]
  v_mfma_f32_16x16x32_bf16 v[124:127], v[156:159], v[52:55], v[124:127]
  s_waitcnt lgkmcnt(7)
  v_readfirstlane_b32 s51, v2
  v_mfma_f32_16x16x32_bf16 v[120:123], v[160:163], v[48:51], v[120:123]
  s_cmp_ge_u32 s51, 3212836871
  s_cbranch_scc0 S_n10
L_n10:
  ds_read_b64_tr_b16 v[96:97], v13 offset:30720
  ds_read_b64_tr_b16 v[98:99], v14 offset:30720
  ds_read_b32 v2, v152 offset:4
  v_mfma_f32_16x16x32_bf16 v[128:131], v[160:163], v[52:55], v[128:131]
  ds_read_b64_tr_b16 v[100:101], v13 offset:30728
  ds_read_b64_tr_b16 v[102:103], v14 offset:30728
  v_mfma_f32_16x16x32_bf16 v[132:135], v[164:167], v[48:51], v[132:135]
  ds_read_b64_tr_b16 v[104:105], v3 offset:30752
  ds_read_b64_tr_b16 v[106:107], v4 offset:30752
  s_waitcnt lgkmcnt(7)
  v_mfma_f32_16x16x32_bf16 v[116:119], v[176:179], v[56:59], v[116:119]
  v_mfma_f32_16x16x32_bf16 v[124:127], v[176:179], v[60:63], v[124:127]
  s_waitcnt lgkmcnt(4)
  v_readfirstlane_b32 s51, v2
  v_mfma_f32_16x16x32_bf16 v[120:123], v[180:183], v[56:59], v[120:123]
  s_cmp_ge_u32 s51, 3212836872
  s_cbranch_scc0 S_n11
L_n11:
  ds_read_b64_tr_b16 v[156:157], v13 offset:35840
  ds_read_b64_tr_b16 v[158:159], v14 offset:35840
  ds_read_b32 v2, v152 offset:4
  v_mfma_f32_16x16x32_bf16 v[128:131], v[180:183], v[60:63], v[128:131]
  ds_read_b64_tr_b16 v[160:161], v13 offset:35848
  ds_read_b64_tr_b16 v[162:163], v14 offset:35848
  v_mfma_f32_16x16x32_bf16 v[132:135], v[184:187], v[56:59], v[132:135]
  ds_read_b64_tr_b16 v[164:165], v3 offset:35872
  ds_read_b64_tr_b16 v[166:167], v4 offset:35872
  s_waitcnt lgkmcnt(7)
  v_mfma_f32_16x16x32_bf16 v[116:119], v[96:99], v[64:67], v[116:119]
  v_mfma_f32_16x16x32_bf16 v[124:127], v[96:99], v[68:71], v[124:127]
  s_waitcnt lgkmcnt(4)
  v_readfirstlane_b32 s51, v2
  v_mfma_f32_16x16x32_bf16 v[120:123], v[100:103], v[64:67], v[120:123]
  s_cmp_ge_u32 s51, 3212836873
  s_cbranch_scc0 S_n12
L_n12:
  ds_read_b64_tr_b16 v[176:177], v13 offset:40960
  ds_read_b64_tr_b16 v[178:179], v14 offset:40960
  ds_read_b32 v2, v152 offset:4
  v_mfma_f32_16x16x32_bf16 v[128:131], v[100:103], v[68:71], v[128:131]
  ds_read_b64_tr_b16 v[180:181], v13 offset:40968
  ds_read_b64_tr_b16 v[182:183], v14 offset:40968
  v_mfma_f32_16x16x32_bf16 v[132:135], v[104:107], v[64:67], v[132:135]
  ds_read_b64_tr_b16 v[184:185], v3 offset:40992
  ds_read_b64_tr_b16 v[186:187], v4 offset:40992
  s_waitcnt lgkmcnt(7)
  v_mfma_f32_16x16x32_bf16 v[116:119], v[156:159], v[72:75], v[116:119]
  v_mfma_f32_16x16x32_bf16 v[124:127], v[156:159], v[76:79], v[124:127]
  s_waitcnt lgkmcnt(4)
  v_readfirstlane_b32 s51, v2
  v_mfma_f32_16x16x32_bf16 v[120:123], v[160:163], v[72:75], v[120:123]
  s_cmp_ge_u32 s51, 3212836874
  s_cbranch_scc0 S_n13
L_n13:
  ds_read_b64_tr_b16 v[96:97], v13 offset:46080
  ds_read_b64_tr_b16 v[98:99], v14 offset:46080
  ds_read_b32 v2, v152 offset:4
  v_mfma_f32_16x16x32_bf16 v[128:131], v[160:163], v[76:79], v[128:131]
  ds_read_b64_tr_b16 v[100:101], v13 offset:46088
  ds_read_b64_tr_b16 v[102:103], v14 offset:46088
  v_mfma_f32_16x16x32_bf16 v[132:135], v[164:167], v[72:75], v[132:135]
  ds_read_b64_tr_b16 v[104:105], v3 offset:46112
  ds_read_b64_tr_b16 v[106:107], v4 offset:46112
  s_waitcnt lgkmcnt(7)
  v_mfma_f32_16x16x32_bf16 v[116:119], v[176:179], v[80:83], v[116:119]
  v_mfma_f32_16x16x32_bf16 v[124:127], v[176:179], v[84:87], v[124:127]
  s_waitcnt lgkmcnt(4)
  v_readfirstlane_b32 s51, v2
  v_mfma_f32_16x16x32_bf16 v[120:123], v[180:183], v[80:83], v[120:123]
  s_cmp_ge_u32 s51, 3212836875
  s_cbranch_scc0 S_n14
L_n14:
  v_add_u32 v13, 51200, v13
  v_add_u32 v14, 51200, v14
  v_add_u32 v3, 51200, v3
  v_add_u32 v4, 51200, v4
  ds_read_b64_tr_b16 v[156:157], v13 offset:0
  ds_read_b64_tr_b16 v[158:159], v14 offset:0
  ds_read_b32 v2, v152 offset:4
  v_mfma_f32_16x16x32_bf16 v[128:131], v[180:183], v[84:87], v[128:131]
  ds_read_b64_tr_b16 v[160:161], v13 offset:8
  ds_read_b64_tr_b16 v[162:163], v14 offset:8
  v_mfma_f32_16x16x32_bf16 v[132:135], v[184:187], v[80:83], v[132:135]
  ds_read_b64_tr_b16 v[164:165], v3 offset:32
  ds_read_b64_tr_b16 v[166:167], v4 offset:32
  s_waitcnt lgkmcnt(7)
  v_mfma_f32_16x16x32_bf16 v[116:119], v[96:99], v[88:91], v[116:119]
  v_mfma_f32_16x16x32_bf16 v[124:127], v[96:99], v[92:95], v[124:127]
  s_waitcnt lgkmcnt(4)
  v_readfirstlane_b32 s51, v2
  v_mfma_f32_16x16x32_bf16 v[120:123], v[100:103], v[88:91], v[120:123]
  s_cmp_ge_u32 s51, 3212836876
  s_cbranch_scc0 S_n15
L_n15:
  ds_read_b64_tr_b16 v[176:177], v13 offset:5120
  ds_read_b64_tr_b16 v[178:179], v14 offset:5120
  ds_read_b32 v2, v152 offset:4
  v_mfma_f32_16x16x32_bf16 v[128:131], v[100:103], v[92:95], v[128:131]
  ds_read_b64_tr_b16 v[180:181], v13 offset:5128
  ds_read_b64_tr_b16 v[182:183], v14 offset:5128
  v_mfma_f32_16x16x32_bf16 v[132:135], v[104:107], v[88:91], v[132:135]
  ds_read_b64_tr_b16 v[184:185], v3 offset:5152
  ds_read_b64_tr_b16 v[186:187], v4 offset:5152
  s_waitcnt lgkmcnt(7)
  v_mfma_f32_16x16x32_bf16 v[116:119], v[156:159], v[196:199], v[116:119]
  v_mfma_f32_16x16x32_bf16 v[124:127], v[156:159], v[200:203], v[124:127]
  s_waitcnt lgkmcnt(4)
  v_readfirstlane_b32 s51, v2
  v_mfma_f32_16x16x32_bf16 v[120:123], v[160:163], v[196:199], v[120:123]
  s_cmp_ge_u32 s51, 3212836877
  s_cbranch_scc0 S_n16
L_n16:
  ds_read_b64_tr_b16 v[96:97], v13 offset:10240
  ds_read_b64_tr_b16 v[98:99], v14 offset:10240
  ds_read_b32 v2, v152 offset:4
  v_mfma_f32_16x16x32_bf16 v[128:131], v[160:163], v[200:203], v[128:131]
  ds_read_b64_tr_b16 v[100:101], v13 offset:10248
  ds_read_b64_tr_b16 v[102:103], v14 offset:10248
  v_mfma_f32_16x16x32_bf16 v[132:135], v[164:167], v[196:199], v[132:135]
  ds_read_b64_tr_b16 v[104:105], v3 offset:10272
  ds_read_b64_tr_b16 v[106:107], v4 offset:10272
  s_waitcnt lgkmcnt(7)
  v_mfma_f32_16x16x32_bf16 v[116:119], v[176:179], v[204:207], v[116:119]
  v_mfma_f32_16x16x32_bf16 v[124:127], v[176:179], v[208:211], v[124:127]
  s_waitcnt lgkmcnt(4)
  v_readfirstlane_b32 s51, v2
  v_mfma_f32_16x16x32_bf16 v[120:123], v[180:183], v[204:207], v[120:123]
  s_cmp_ge_u32 s51, 3212836878
  s_cbranch_scc0 S_n17
L_n17:
  ds_read_b64_tr_b16 v[156:157], v13 offset:15360
  ds_read_b64_tr_b16 v[158:159], v14 offset:15360
  ds_read_b32 v2, v152 offset:4
  v_mfma_f32_16x16x32_bf16 v[128:131], v[180:183], v[208:211], v[128:131]
  ds_read_b64_tr_b16 v[160:161], v13 offset:15368
  ds_read_b64_tr_b16 v[162:163], v14 offset:15368
  v_mfma_f32_16x16x32_bf16 v[132:135], v[184:187], v[204:207], v[132:135]
  ds_read_b64_tr_b16 v[164:165], v3 offset:15392
  ds_read_b64_tr_b16 v[166:167], v4 offset:15392
  s_waitcnt lgkmcnt(7)
  v_mfma_f32_16x16x32_bf16 v[116:119], v[96:99], v[212:215], v[116:119]
  v_mfma_f32_16x16x32_bf16 v[124:127], v[96:99], v[216:219], v[124:127]
  s_waitcnt lgkmcnt(4)
  v_readfirstlane_b32 s51, v2
  v_mfma_f32_16x16x32_bf16 v[120:123], v[100:103], v[212:215], v[120:123]
  s_cmp_ge_u32 s51, 3212836879
  s_cbranch_scc0 S_n18
L_n18:
  ds_read_b64_tr_b16 v[176:177], v13 offset:20480
  ds_read_b64_tr_b16 v[178:179], v14 offset:20480
  ds_read_b32 v2, v152 offset:4
  v_mfma_f32_16x16x32_bf16 v[128:131], v[100:103], v[216:219], v[128:131]
  ds_read_b64_tr_b16 v[180:181], v13 offset:20488
  ds_read_b64_tr_b16 v[182:183], v14 offset:20488
  v_mfma_f32_16x16x32_bf16 v[132:135], v[104:107], v[212:215], v[132:135]
  ds_read_b64_tr_b16 v[184:185], v3 offset:20512
  ds_read_b64_tr_b16 v[186:187], v4 offset:20512
  s_waitcnt lgkmcnt(7)
  v_mfma_f32_16x16x32_bf16 v[116:119], v[156:159], v[220:223], v[116:119]
  v_mfma_f32_16x16x32_bf16 v[124:127], v[156:159], v[224:227], v[124:127]
  s_waitcnt lgkmcnt(4)
  v_readfirstlane_b32 s51, v2
  v_mfma_f32_16x16x32_bf16 v[120:123], v[160:163], v[220:223], v[120:123]
  s_cmp_ge_u32 s51, 3212836880
  s_cbranch_scc0 S_n19
L_n19:
  ds_read_b64_tr_b16 v[96:97], v13 offset:25600
  ds_read_b64_tr_b16 v[98:99], v14 offset:25600
  v_mfma_f32_16x16x32_bf16 v[128:131], v[160:163], v[224:227], v[128:131]
  ds_read_b64_tr_b16 v[100:101], v13 offset:25608
  ds_read_b64_tr_b16 v[102:103], v14 offset:25608
  v_mfma_f32_16x16x32_bf16 v[132:135], v[164:167], v[220:223], v[132:135]
  ds_read_b64_tr_b16 v[104:105], v3 offset:25632
  ds_read_b64_tr_b16 v[106:107], v4 offset:25632
  s_waitcnt lgkmcnt(6)
  v_mfma_f32_16x16x32_bf16 v[116:119], v[176:179], v[108:111], v[116:119]
  v_mfma_f32_16x16x32_bf16 v[124:127], v[176:179], v[112:115], v[124:127]
  ds_read_b32 v2, v152 offset:4
  v_mfma_f32_16x16x32_bf16 v[120:123], v[180:183], v[108:111], v[120:123]
  v_mov_b64 v[196:197], 0
  v_mfma_f32_16x16x32_bf16 v[128:131], v[180:183], v[112:115], v[128:131]
  v_mov_b64 v[198:199], 0
  v_mfma_f32_16x16x32_bf16 v[132:135], v[184:187], v[108:111], v[132:135]
  v_mov_b64 v[200:201], 0
  s_waitcnt lgkmcnt(1)
  v_mfma_f32_16x16x32_bf16 v[116:119], v[96:99], v[168:171], v[116:119]
  s_waitcnt lgkmcnt(0)
  v_readfirstlane_b32 s51, v2
  v_mov_b64 v[202:203], 0
  v_mfma_f32_16x16x32_bf16 v[124:127], v[96:99], v[172:175], v[124:127]
  s_cmp_ge_u32 s51, 3212836881
  s_cbranch_scc0 S_n20
L_n20:
  ds_read_b64_tr_b16 v[156:157], v13 offset:30720
  ds_read_b64_tr_b16 v[158:159], v14 offset:30720
  ds_read_b64_tr_b16 v[160:161], v13 offset:30728
  ds_read_b64_tr_b16 v[162:163], v14 offset:30728
  ds_read_b64_tr_b16 v[164:165], v3 offset:30752
  ds_read_b64_tr_b16 v[166:167], v4 offset:30752
  ds_read_b32 v2, v152 offset:4
  v_mov_b64 v[204:205], 0
  v_mfma_f32_16x16x32_bf16 v[120:123], v[100:103], v[168:171], v[120:123]
  v_mov_b64 v[206:207], 0
  v_mfma_f32_16x16x32_bf16 v[128:131], v[100:103], v[172:175], v[128:131]
  v_mov_b64 v[208:209], 0
  v_mfma_f32_16x16x32_bf16 v[132:135], v[104:107], v[168:171], v[132:135]
  v_mov_b64 v[210:211], 0
  s_waitcnt lgkmcnt(5)
  v_mfma_f32_16x16x32_bf16 v[116:119], v[156:159], v[16:19], v[116:119]
  s_waitcnt lgkmcnt(0)
  v_readfirstlane_b32 s51, v2
  v_mov_b64 v[212:213], 0
  v_mfma_f32_16x16x32_bf16 v[124:127], v[156:159], v[20:23], v[124:127]
  s_cmp_ge_u32 s51, 3212836882
  s_cbranch_scc0 S_n21
L_n21:
  ds_read_b64_tr_b16 v[176:177], v13 offset:35840
  ds_read_b64_tr_b16 v[178:179], v14 offset:35840
  ds_read_b64_tr_b16 v[180:181], v13 offset:35848
  ds_read_b64_tr_b16 v[182:183], v14 offset:35848
  ds_read_b64_tr_b16 v[184:185], v3 offset:35872
  ds_read_b64_tr_b16 v[186:187], v4 offset:35872
  ds_read_b32 v2, v152 offset:4
  v_mov_b64 v[214:215], 0
  v_mfma_f32_16x16x32_bf16 v[120:123], v[160:163], v[16:19], v[120:123]
  v_mov_b64 v[216:217], 0
  v_mfma_f32_16x16x32_bf16 v[128:131], v[160:163], v[20:23], v[128:131]
  v_mov_b64 v[218:219], 0
  v_mfma_f32_16x16x32_bf16 v[132:135], v[164:167], v[16:19], v[132:135]
  v_mov_b64 v[220:221], 0
  s_waitcnt lgkmcnt(5)
  v_mfma_f32_16x16x32_bf16 v[116:119], v[176:179], v[24:27], v[116:119]
  s_waitcnt lgkmcnt(0)
  v_readfirstlane_b32 s51, v2
  v_mov_b64 v[222:223], 0
  v_mfma_f32_16x16x32_bf16 v[124:127], v[176:179], v[28:31], v[124:127]
  s_cmp_ge_u32 s51, 3212836883
  s_cbranch_scc0 S_n22
L_n22:
  ds_read_b64_tr_b16 v[96:97], v13 offset:40960
  ds_read_b64_tr_b16 v[98:99], v14 offset:40960
  ds_read_b64_tr_b16 v[100:101], v13 offset:40968
  ds_read_b64_tr_b16 v[102:103], v14 offset:40968
  ds_read_b64_tr_b16 v[104:105], v3 offset:40992
  ds_read_b64_tr_b16 v[106:107], v4 offset:40992
  ds_read_b32 v2, v152 offset:4
  v_mov_b64 v[224:225], 0
  v_mfma_f32_16x16x32_bf16 v[120:123], v[180:183], v[24:27], v[120:123]
  v_mov_b64 v[226:227], 0
  v_mfma_f32_16x16x32_bf16 v[128:131], v[180:183], v[28:31], v[128:131]
  v_mfma_f32_16x16x32_bf16 v[132:135], v[184:187], v[24:27], v[132:135]
  s_waitcnt lgkmcnt(5)
  v_mfma_f32_16x16x32_bf16 v[116:119], v[96:99], v[32:35], v[116:119]
  s_waitcnt lgkmcnt(0)
  v_readfirstlane_b32 s51, v2
  v_mfma_f32_16x16x32_bf16 v[124:127], v[96:99], v[36:39], v[124:127]
  s_cmp_ge_u32 s51, 3212836884
  s_cbranch_scc0 S_n23
L_n23:
  ds_read_b64_tr_b16 v[156:157], v13 offset:46080
  ds_read_b64_tr_b16 v[158:159], v14 offset:46080
  ds_read_b64_tr_b16 v[160:161], v13 offset:46088
  ds_read_b64_tr_b16 v[162:163], v14 offset:46088
  ds_read_b64_tr_b16 v[164:165], v3 offset:46112
  ds_read_b64_tr_b16 v[166:167], v4 offset:46112
  v_mfma_f32_16x16x32_bf16 v[120:123], v[100:103], v[32:35], v[120:123]
  v_mfma_f32_16x16x32_bf16 v[128:131], v[100:103], v[36:39], v[128:131]
  v_mfma_f32_16x16x32_bf16 v[132:135], v[104:107], v[32:35], v[132:135]
  s_waitcnt lgkmcnt(4)
  v_mfma_f32_16x16x32_bf16 v[116:119], v[156:159], v[40:43], v[116:119]
  v_mfma_f32_16x16x32_bf16 v[124:127], v[156:159], v[44:47], v[124:127]
  s_waitcnt lgkmcnt(2)
  v_mfma_f32_16x16x32_bf16 v[120:123], v[160:163], v[40:43], v[120:123]
  v_mfma_f32_16x16x32_bf16 v[128:131], v[160:163], v[44:47], v[128:131]
  s_waitcnt lgkmcnt(0)
  v_mfma_f32_16x16x32_bf16 v[132:135], v[164:167], v[40:43], v[132:135]
  v_cvt_pk_bf16_f32 v176, v116, v117
  v_cvt_pk_bf16_f32 v177, v118, v119
  v_cvt_pk_bf16_f32 v178, v120, v121
  v_cvt_pk_bf16_f32 v179, v122, v123
  ds_write_b128 v15, v[176:179]
  v_cvt_pk_bf16_f32 v180, v124, v125
  v_cvt_pk_bf16_f32 v181, v126, v127
  v_cvt_pk_bf16_f32 v182, v128, v129
  v_cvt_pk_bf16_f32 v183, v130, v131
  ds_write_b128 v254, v[180:183] offset:256
  v_cvt_pk_bf16_f32 v184, v132, v133
  v_cvt_pk_bf16_f32 v185, v134, v135
  ds_write_b64 v255, v[184:185] offset:1024
  s_mov_b32 s32, s12
  s_and_b32 s33, s13, 0xffff
  s_and_b32 s56, s23, 1
  s_lshl_b32 s56, s56, 3
  s_lshr_b32 s57, s23, 1
  s_add_u32 s56, s56, s57
  s_mul_i32 s56, s56, 51200
  s_mul_i32 s57, s23, 25600
  s_mul_i32 s25, s24, 102400
  s_add_u32 s52, s56, s25
  s_add_u32 s54, s52, 204800
  s_mul_i32 s25, s24, 5120
  s_add_u32 s53, s57, s25
  s_add_u32 s55, s53, 10240
  s_lshl_b32 s25, s24, 11
  s_add_u32 s57, s57, s25
  s_add_u32 s57, s57, 20480
  s_lshl_b32 s26, s20, 2
  s_and_b32 s27, s23, 2
  s_add_u32 s26, s26, s27
  s_add_u32 s26, s26, s24
  s_mul_i32 s26, s26, 20480
  s_add_u32 s4, s26, 1048576
  s_lshr_b32 s27, s21, 1
  s_mul_i32 s27, s27, 5120
  s_add_u32 s26, s4, s27
  s_and_b32 s5, s21, 1
  s_and_b32 s6, s23, 1
  s_lshl1_add_u32 s5, s5, s6
  s_lshl_b32 s28, s5, 10
  s_add_u32 s28, s28, s26
  s_lshl_b32 s29, s5, 8
  s_add_u32 s29, s29, s26
  s_add_u32 s29, s29, 4096
  s_mul_i32 s30, s5, -768
  s_add_u32 s30, s30, 3072
  s_add_u32 s5, s4, 5120
  s_add_u32 s6, s4, 10240
  s_add_u32 s7, s4, 15360
  s_mov_b32 s36, 8
L_b2b:
  s_waitcnt lgkmcnt(0)
  s_barrier
  ds_read_b128 v[16:19], v250
  ds_read_b128 v[28:31], v232
  s_mov_b32 exec_hi, 0
  ds_read_b64 v[228:229], v252 offset:1024
  ds_read_b64 v[230:231], v253 offset:1024
  s_mov_b64 exec, -1
  ds_read_b64 v[32:33], v233
  ds_read_b128 v[20:23], v251
  ds_read_b32 v7, v152 offset:12
  ds_read_b128 v[120:123], v234
  ds_read_b128 v[124:127], v234 offset:768
A_start:
  s_lshl_b32 s51, s3, 15
  s_add_u32 s51, s51, s50
  s_mov_b32 s49, 0
  s_setprio 2
  s_waitcnt lgkmcnt(7)
  v_mfma_f32_32x32x16_bf16 v[56:71], v[28:31], v[16:19], 0
  s_waitcnt lgkmcnt(4)
  v_mfma_f32_32x32x8_bf16 v[56:71], v[32:33], v[228:229], v[56:71]
  s_waitcnt lgkmcnt(2)
  s_nop 9
  v_mfma_f32_32x32x8_bf16 v[72:87], v[32:33], v[230:231], 0
  v_exp_f32 v56, v56
  v_exp_f32 v57, v57
  v_exp_f32 v58, v58
  v_exp_f32 v59, v59
  v_mfma_f32_32x32x16_bf16 v[72:87], v[28:31], v[20:23], v[72:87]
  v_cmp_ne_u32 vcc, 0, v7
  s_xor_b32 s51, s51, 32768
  s_add_u32 m0, s50, 128512
  v_exp_f32 v60, v60
  v_exp_f32 v61, v61
  v_exp_f32 v62, v62
  v_exp_f32 v63, v63
  s_cbranch_vccnz S_p0
  buffer_load_dwordx4 v6, s[40:43], s51 offen offset:0 sc1 lds
A_p0:
  v_exp_f32 v64, v64
  v_exp_f32 v65, v65
  v_exp_f32 v66, v66
  v_exp_f32 v67, v67
  ds_read_b128 v[28:31], v232 offset:3072
  ds_read_b64 v[32:33], v233 offset:3072
  v_exp_f32 v68, v68
  v_exp_f32 v69, v69
  v_exp_f32 v70, v70
  v_exp_f32 v71, v71
  s_waitcnt lgkmcnt(0)
  v_mfma_f32_32x32x8_bf16 v[88:103], v[32:33], v[228:229], 0
  v_exp_f32 v72, v72
  v_exp_f32 v73, v73
  v_exp_f32 v74, v74
  v_exp_f32 v75, v75
  v_mfma_f32_32x32x16_bf16 v[88:103], v[28:31], v[16:19], v[88:103]
  ds_read_b128 v[128:131], v234 offset:3072
  ds_read_b128 v[132:135], v234 offset:3840
  v_exp_f32 v76, v76
  v_exp_f32 v77, v77
  v_exp_f32 v78, v78
  v_exp_f32 v79, v79
  v_smfmac_f32_32x32x32_bf16 v[196:211], v[120:123], v[56:63], v5
  s_cbranch_vccnz A_p1
  buffer_load_dwordx4 v6, s[40:43], s51 offen offset:1024 sc1 lds
A_p1:
  v_exp_f32 v80, v80
  v_exp_f32 v81, v81
  v_exp_f32 v82, v82
  v_exp_f32 v83, v83
  v_smfmac_f32_32x32x32_bf16 v[196:211], v[124:127], v[64:71], v5
  v_exp_f32 v84, v84
  v_exp_f32 v85, v85
  v_exp_f32 v86, v86
  v_exp_f32 v87, v87
  v_mfma_f32_32x32x8_bf16 v[104:119], v[32:33], v[230:231], 0
  v_exp_f32 v88, v88
  v_exp_f32 v89, v89
  v_exp_f32 v90, v90
  v_exp_f32 v91, v91
  v_mfma_f32_32x32x16_bf16 v[104:119], v[28:31], v[20:23], v[104:119]
  v_exp_f32 v92, v92
  v_exp_f32 v93, v93
  v_exp_f32 v94, v94
  v_exp_f32 v95, v95
  v_smfmac_f32_32x32x32_bf16 v[212:227], v[120:123], v[72:79], v5
  s_cbranch_vccnz S_p2
A_p2:
  buffer_load_dwordx4 v6, s[40:43], s51 offen offset:2048 sc1 lds
  v_exp_f32 v96, v96
  v_exp_f32 v97, v97
  v_exp_f32 v98, v98
  v_exp_f32 v99, v99
  v_smfmac_f32_32x32x32_bf16 v[212:227], v[124:127], v[80:87], v5
  ds_read_b128 v[28:31], v232 offset:6144
  ds_read_b64 v[32:33], v233 offset:6144
  v_exp_f32 v100, v100
  s_setprio 1
  v_exp_f32 v101, v101
  v_exp_f32 v102, v102
  v_exp_f32 v103, v103
  s_waitcnt lgkmcnt(0)
  v_mfma_f32_32x32x8_bf16 v[56:71], v[32:33], v[228:229], 0
  v_exp_f32 v104, v104
  v_exp_f32 v105, v105
  v_exp_f32 v106, v106
  v_exp_f32 v107, v107
  v_mfma_f32_32x32x16_bf16 v[56:71], v[28:31], v[16:19], v[56:71]
  ds_read_b128 v[120:123], v234 offset:6144
  ds_read_b128 v[124:127], v234 offset:6912
  v_exp_f32 v108, v108
  v_exp_f32 v109, v109
  v_exp_f32 v110, v110
  v_exp_f32 v111, v111
  v_smfmac_f32_32x32x32_bf16 v[196:211], v[128:131], v[88:95], v5
  v_exp_f32 v112, v112
  v_exp_f32 v113, v113
  v_exp_f32 v114, v114
  v_exp_f32 v115, v115
  v_smfmac_f32_32x32x32_bf16 v[196:211], v[132:135], v[96:103], v5
  v_exp_f32 v116, v116
  v_exp_f32 v117, v117
  v_exp_f32 v118, v118
  v_exp_f32 v119, v119
  v_mfma_f32_32x32x8_bf16 v[72:87], v[32:33], v[230:231], 0
  v_exp_f32 v56, v56
  v_exp_f32 v57, v57
  v_exp_f32 v58, v58
  v_exp_f32 v59, v59
  v_mfma_f32_32x32x16_bf16 v[72:87], v[28:31], v[20:23], v[72:87]
  s_mov_b32 s27, 262144
  v_exp_f32 v60, v60
  v_exp_f32 v61, v61
  v_exp_f32 v62, v62
  v_exp_f32 v63, v63
  v_smfmac_f32_32x32x32_bf16 v[212:227], v[128:131], v[104:111], v5
  buffer_load_dwordx4 v[148:151], v145, s[40:43], s27 offen sc1
  v_exp_f32 v64, v64
  v_exp_f32 v65, v65
  v_exp_f32 v66, v66
  v_exp_f32 v67, v67
  v_smfmac_f32_32x32x32_bf16 v[212:227], v[132:135], v[112:119], v5
  ds_read_b128 v[28:31], v232 offset:9216
  ds_read_b64 v[32:33], v233 offset:9216
  v_exp_f32 v68, v68
  s_setprio 0
  v_exp_f32 v69, v69
  v_exp_f32 v70, v70
  v_exp_f32 v71, v71
  s_waitcnt lgkmcnt(0)
  v_mfma_f32_32x32x8_bf16 v[88:103], v[32:33], v[228:229], 0
  v_exp_f32 v72, v72
  v_exp_f32 v73, v73
  v_exp_f32 v74, v74
  v_exp_f32 v75, v75
  v_mfma_f32_32x32x16_bf16 v[88:103], v[28:31], v[16:19], v[88:103]
  ds_read_b128 v[128:131], v234 offset:9216
  ds_read_b128 v[132:135], v234 offset:9984
  v_exp_f32 v76, v76
  v_exp_f32 v77, v77
  v_exp_f32 v78, v78
  v_exp_f32 v79, v79
  v_smfmac_f32_32x32x32_bf16 v[196:211], v[120:123], v[56:63], v5
  v_exp_f32 v80, v80
  v_exp_f32 v81, v81
  v_exp_f32 v82, v82
  v_exp_f32 v83, v83
  v_smfmac_f32_32x32x32_bf16 v[196:211], v[124:127], v[64:71], v5
  v_exp_f32 v84, v84
  v_exp_f32 v85, v85
  v_exp_f32 v86, v86
  v_exp_f32 v87, v87
  v_mfma_f32_32x32x8_bf16 v[104:119], v[32:33], v[230:231], 0
  v_exp_f32 v88, v88
  v_exp_f32 v89, v89
  v_exp_f32 v90, v90
  s_waitcnt vmcnt(1) lgkmcnt(0)
  s_barrier
  s_setprio 3
  v_exp_f32 v91, v91
  v_mfma_f32_32x32x16_bf16 v[104:119], v[28:31], v[20:23], v[104:119]
  ds_read_b128 v[28:31], v232 offset:26112
  ds_read_b64 v[32:33], v233 offset:26112
  v_exp_f32 v92, v92
  v_exp_f32 v93, v93
  v_exp_f32 v94, v94
  v_exp_f32 v95, v95
  v_smfmac_f32_32x32x32_bf16 v[212:227], v[120:123], v[72:79], v5
  v_exp_f32 v96, v96
  v_exp_f32 v97, v97
  v_exp_f32 v98, v98
  v_exp_f32 v99, v99
  v_smfmac_f32_32x32x32_bf16 v[212:227], v[124:127], v[80:87], v5
  v_exp_f32 v100, v100
  v_exp_f32 v101, v101
  v_exp_f32 v102, v102
  v_exp_f32 v103, v103
  s_waitcnt lgkmcnt(0)
  v_mfma_f32_32x32x8_bf16 v[56:71], v[32:33], v[228:229], 0
  v_exp_f32 v104, v104
  v_exp_f32 v105, v105
  v_exp_f32 v106, v106
  s_waitcnt vmcnt(0)
A_pc:
  v_bitop3_b32 v1, v148, v149, s62 bitop3:0x7e
  v_bitop3_b32 v2, v150, v151, s62 bitop3:0x7e
  v_or_b32 v1, v1, v2
  v_cmp_lt_u32 vcc, 15, v1
  s_cbranch_vccnz S_pc
A_pc_ok:
  v_mov_b64 v[148:149], -1
  v_mov_b64 v[150:151], -1
  s_cmp_lg_u32 s60, 0
  v_exp_f32 v107, v107
  v_mfma_f32_32x32x16_bf16 v[56:71], v[28:31], v[16:19], v[56:71]
  ds_read_b128 v[120:123], v234 offset:26112
  ds_read_b128 v[124:127], v234 offset:26880
  v_exp_f32 v108, v108
  v_exp_f32 v109, v109
  v_exp_f32 v110, v110
  v_exp_f32 v111, v111
  v_smfmac_f32_32x32x32_bf16 v[196:211], v[128:131], v[88:95], v5
  s_cbranch_scc1 A_nosent
  buffer_store_dwordx4 v[148:151], v6, s[40:43], s28 offen sc1
  s_mov_b32 exec_hi, 0
  buffer_store_dwordx2 v[148:149], v147, s[40:43], s29 offen sc1
  s_mov_b64 exec, -1
A_nosent:
  v_exp_f32 v112, v112
  v_exp_f32 v113, v113
  v_exp_f32 v114, v114
  v_exp_f32 v115, v115
  v_smfmac_f32_32x32x32_bf16 v[196:211], v[132:135], v[96:103], v5
  v_exp_f32 v116, v116
  v_exp_f32 v117, v117
  v_exp_f32 v118, v118
  v_exp_f32 v119, v119
  v_mfma_f32_32x32x8_bf16 v[72:87], v[32:33], v[230:231], 0
  v_exp_f32 v56, v56
  v_exp_f32 v57, v57
  v_exp_f32 v58, v58
  v_exp_f32 v59, v59
  v_mfma_f32_32x32x16_bf16 v[72:87], v[28:31], v[20:23], v[72:87]
  s_xor_b32 s51, s51, 98304
  s_add_u32 m0, s50, 102400
  v_exp_f32 v60, v60
  v_exp_f32 v61, v61
  v_exp_f32 v62, v62
  v_exp_f32 v63, v63
  v_smfmac_f32_32x32x32_bf16 v[212:227], v[128:131], v[104:111], v5
  buffer_load_dwordx4 v6, s[40:43], s51 offen offset:0 sc1 lds
  v_exp_f32 v64, v64
  v_exp_f32 v65, v65
  v_exp_f32 v66, v66
  v_exp_f32 v67, v67
  v_smfmac_f32_32x32x32_bf16 v[212:227], v[132:135], v[112:119], v5
  ds_read_b128 v[28:31], v232 offset:29184
  ds_read_b64 v[32:33], v233 offset:29184
  v_exp_f32 v68, v68
  s_setprio 2
  v_exp_f32 v69, v69
  v_exp_f32 v70, v70
  v_exp_f32 v71, v71
  s_waitcnt lgkmcnt(0)
  v_mfma_f32_32x32x8_bf16 v[88:103], v[32:33], v[228:229], 0
  v_exp_f32 v72, v72
  v_exp_f32 v73, v73
  v_exp_f32 v74, v74
  v_exp_f32 v75, v75
  v_mfma_f32_32x32x16_bf16 v[88:103], v[28:31], v[16:19], v[88:103]
  ds_read_b128 v[128:131], v234 offset:29184
  ds_read_b128 v[132:135], v234 offset:29952
  v_exp_f32 v76, v76
  v_exp_f32 v77, v77
  v_exp_f32 v78, v78
  v_exp_f32 v79, v79
  v_smfmac_f32_32x32x32_bf16 v[196:211], v[120:123], v[56:63], v5
  buffer_load_dwordx4 v6, s[40:43], s51 offen offset:1024 sc1 lds
  v_exp_f32 v80, v80
  v_exp_f32 v81, v81
  v_exp_f32 v82, v82
  v_exp_f32 v83, v83
  v_smfmac_f32_32x32x32_bf16 v[196:211], v[124:127], v[64:71], v5
  v_exp_f32 v84, v84
  v_exp_f32 v85, v85
  v_exp_f32 v86, v86
  v_exp_f32 v87, v87
  v_mfma_f32_32x32x8_bf16 v[104:119], v[32:33], v[230:231], 0
  v_exp_f32 v88, v88
  v_exp_f32 v89, v89
  v_exp_f32 v90, v90
  v_exp_f32 v91, v91
  v_mfma_f32_32x32x16_bf16 v[104:119], v[28:31], v[20:23], v[104:119]
  v_exp_f32 v92, v92
  v_exp_f32 v93, v93
  v_exp_f32 v94, v94
  v_exp_f32 v95, v95
  v_smfmac_f32_32x32x32_bf16 v[212:227], v[120:123], v[72:79], v5
  buffer_load_dwordx4 v6, s[40:43], s51 offen offset:2048 sc1 lds
  v_exp_f32 v96, v96
  v_exp_f32 v97, v97
  v_exp_f32 v98, v98
  v_exp_f32 v99, v99
  v_smfmac_f32_32x32x32_bf16 v[212:227], v[124:127], v[80:87], v5
  ds_read_b128 v[28:31], v232 offset:32256
  ds_read_b64 v[32:33], v233 offset:32256
  v_exp_f32 v100, v100
  s_setprio 1
  v_exp_f32 v101, v101
  v_exp_f32 v102, v102
  v_exp_f32 v103, v103
  s_waitcnt lgkmcnt(0)
  v_mfma_f32_32x32x8_bf16 v[56:71], v[32:33], v[228:229], 0
  v_exp_f32 v104, v104
  v_exp_f32 v105, v105
  v_exp_f32 v106, v106
  v_exp_f32 v107, v107
  v_mfma_f32_32x32x16_bf16 v[56:71], v[28:31], v[16:19], v[56:71]
  ds_read_b128 v[120:123], v234 offset:32256
  ds_read_b128 v[124:127], v234 offset:33024
  v_exp_f32 v108, v108
  v_exp_f32 v109, v109
  v_exp_f32 v110, v110
  v_exp_f32 v111, v111
  v_smfmac_f32_32x32x32_bf16 v[196:211], v[128:131], v[88:95], v5
  v_exp_f32 v112, v112
  v_exp_f32 v113, v113
  v_exp_f32 v114, v114
  v_exp_f32 v115, v115
  v_smfmac_f32_32x32x32_bf16 v[196:211], v[132:135], v[96:103], v5
  v_exp_f32 v116, v116
  v_exp_f32 v117, v117
  v_exp_f32 v118, v118
  v_exp_f32 v119, v119
  v_mfma_f32_32x32x8_bf16 v[72:87], v[32:33], v[230:231], 0
  v_exp_f32 v56, v56
  v_exp_f32 v57, v57
  v_exp_f32 v58, v58
  v_exp_f32 v59, v59
  v_mfma_f32_32x32x16_bf16 v[72:87], v[28:31], v[20:23], v[72:87]
  v_exp_f32 v60, v60
  v_exp_f32 v61, v61
  v_exp_f32 v62, v62
  v_exp_f32 v63, v63
  v_smfmac_f32_32x32x32_bf16 v[212:227], v[128:131], v[104:111], v5
  v_exp_f32 v64, v64
  v_exp_f32 v65, v65
  v_exp_f32 v66, v66
  v_exp_f32 v67, v67
  v_smfmac_f32_32x32x32_bf16 v[212:227], v[132:135], v[112:119], v5
  ds_read_b128 v[28:31], v232 offset:35328
  ds_read_b64 v[32:33], v233 offset:35328
  v_exp_f32 v68, v68
  s_setprio 0
  v_exp_f32 v69, v69
  v_exp_f32 v70, v70
  v_exp_f32 v71, v71
  s_waitcnt lgkmcnt(0)
  v_mfma_f32_32x32x8_bf16 v[88:103], v[32:33], v[228:229], 0
  v_exp_f32 v72, v72
  v_exp_f32 v73, v73
  v_exp_f32 v74, v74
  v_exp_f32 v75, v75
  v_mfma_f32_32x32x16_bf16 v[88:103], v[28:31], v[16:19], v[88:103]
  ds_read_b128 v[128:131], v234 offset:35328
  ds_read_b128 v[132:135], v234 offset:36096
  v_exp_f32 v76, v76
  v_exp_f32 v77, v77
  v_exp_f32 v78, v78
  v_exp_f32 v79, v79
  v_smfmac_f32_32x32x32_bf16 v[196:211], v[120:123], v[56:63], v5
  v_exp_f32 v80, v80
  v_exp_f32 v81, v81
  v_exp_f32 v82, v82
  v_exp_f32 v83, v83
  v_smfmac_f32_32x32x32_bf16 v[196:211], v[124:127], v[64:71], v5
  v_exp_f32 v84, v84
  v_exp_f32 v85, v85
  v_exp_f32 v86, v86
  v_exp_f32 v87, v87
  v_mfma_f32_32x32x8_bf16 v[104:119], v[32:33], v[230:231], 0
  v_exp_f32 v88, v88
  v_exp_f32 v89, v89
  v_exp_f32 v90, v90
  s_waitcnt vmcnt(0) lgkmcnt(0)
  s_barrier
  s_setprio 3
  v_exp_f32 v91, v91
  v_mfma_f32_32x32x16_bf16 v[104:119], v[28:31], v[20:23], v[104:119]
  ds_read_b128 v[28:31], v232 offset:0
  ds_read_b64 v[32:33], v233 offset:0
  v_exp_f32 v92, v92
  v_exp_f32 v93, v93
  v_exp_f32 v94, v94
  v_exp_f32 v95, v95
  v_smfmac_f32_32x32x32_bf16 v[212:227], v[120:123], v[72:79], v5
  v_exp_f32 v96, v96
  v_exp_f32 v97, v97
  v_exp_f32 v98, v98
  v_exp_f32 v99, v99
  v_smfmac_f32_32x32x32_bf16 v[212:227], v[124:127], v[80:87], v5
  v_exp_f32 v100, v100
  v_exp_f32 v101, v101
  v_exp_f32 v102, v102
  v_exp_f32 v103, v103
  s_waitcnt lgkmcnt(0)
  v_mfma_f32_32x32x8_bf16 v[56:71], v[32:33], v[228:229], 0
  v_exp_f32 v104, v104
  v_exp_f32 v105, v105
  v_exp_f32 v106, v106
  v_min_u32 v1, 1152, v144
  v_lshrrev_b32 v2, 10, v1
  v_mad_u32_u24 v1, v2, s30, v1
  s_cmp_eq_u32 s22, 0
  s_cbranch_scc1 S_f2
A_f2:
  v_exp_f32 v107, v107
  v_mfma_f32_32x32x16_bf16 v[56:71], v[28:31], v[16:19], v[56:71]
  ds_read_b128 v[120:123], v234 offset:0
  ds_read_b128 v[124:127], v234 offset:768
  v_exp_f32 v108, v108
  v_exp_f32 v109, v109
  v_exp_f32 v110, v110
  v_exp_f32 v111, v111
  v_smfmac_f32_32x32x32_bf16 v[196:211], v[128:131], v[88:95], v5
  buffer_load_dword v235, v1, s[40:43], s28 offen sc1
  v_exp_f32 v112, v112
  v_exp_f32 v113, v113
  v_exp_f32 v114, v114
  v_exp_f32 v115, v115
  v_smfmac_f32_32x32x32_bf16 v[196:211], v[132:135], v[96:103], v5
  v_exp_f32 v116, v116
  v_exp_f32 v117, v117
  v_exp_f32 v118, v118
  v_exp_f32 v119, v119
  v_mfma_f32_32x32x8_bf16 v[72:87], v[32:33], v[230:231], 0
  v_exp_f32 v56, v56
  v_exp_f32 v57, v57
  v_exp_f32 v58, v58
  v_exp_f32 v59, v59
  v_mfma_f32_32x32x16_bf16 v[72:87], v[28:31], v[20:23], v[72:87]
  s_xor_b32 s51, s51, 32768
  s_add_u32 m0, s50, 128512
  v_exp_f32 v60, v60
  v_exp_f32 v61, v61
  v_exp_f32 v62, v62
  v_exp_f32 v63, v63
  v_smfmac_f32_32x32x32_bf16 v[212:227], v[128:131], v[104:111], v5
  buffer_load_dwordx4 v6, s[40:43], s51 offen offset:0 sc1 lds
  v_exp_f32 v64, v64
  v_exp_f32 v65, v65
  v_exp_f32 v66, v66
  v_exp_f32 v67, v67
  v_smfmac_f32_32x32x32_bf16 v[212:227], v[132:135], v[112:119], v5
  ds_read_b128 v[28:31], v232 offset:3072
  ds_read_b64 v[32:33], v233 offset:3072
  v_exp_f32 v68, v68
  s_setprio 2
  v_exp_f32 v69, v69
  v_exp_f32 v70, v70
  v_exp_f32 v71, v71
  s_waitcnt lgkmcnt(0)
  v_mfma_f32_32x32x8_bf16 v[88:103], v[32:33], v[228:229], 0
  v_exp_f32 v72, v72
  v_exp_f32 v73, v73
  v_exp_f32 v74, v74
  v_exp_f32 v75, v75
  v_mfma_f32_32x32x16_bf16 v[88:103], v[28:31], v[16:19], v[88:103]
  ds_read_b128 v[128:131], v234 offset:3072
  ds_read_b128 v[132:135], v234 offset:3840
  v_exp_f32 v76, v76
  v_exp_f32 v77, v77
  v_exp_f32 v78, v78
  v_exp_f32 v79, v79
  v_smfmac_f32_32x32x32_bf16 v[196:211], v[120:123], v[56:63], v5
  buffer_load_dwordx4 v6, s[40:43], s51 offen offset:1024 sc1 lds
  v_exp_f32 v80, v80
  v_exp_f32 v81, v81
  v_exp_f32 v82, v82
  v_exp_f32 v83, v83
  v_smfmac_f32_32x32x32_bf16 v[196:211], v[124:127], v[64:71], v5
  v_exp_f32 v84, v84
  v_exp_f32 v85, v85
  v_exp_f32 v86, v86
  v_exp_f32 v87, v87
  v_mfma_f32_32x32x8_bf16 v[104:119], v[32:33], v[230:231], 0
  v_exp_f32 v88, v88
  v_exp_f32 v89, v89
  v_exp_f32 v90, v90
  v_exp_f32 v91, v91
  v_mfma_f32_32x32x16_bf16 v[104:119], v[28:31], v[20:23], v[104:119]
  v_exp_f32 v92, v92
  v_exp_f32 v93, v93
  v_exp_f32 v94, v94
  v_exp_f32 v95, v95
  v_smfmac_f32_32x32x32_bf16 v[212:227], v[120:123], v[72:79], v5
  buffer_load_dwordx4 v6, s[40:43], s51 offen offset:2048 sc1 lds
  v_exp_f32 v96, v96
  v_exp_f32 v97, v97
  v_exp_f32 v98, v98
  v_exp_f32 v99, v99
  v_smfmac_f32_32x32x32_bf16 v[212:227], v[124:127], v[80:87], v5
  ds_read_b128 v[28:31], v232 offset:6144
  ds_read_b64 v[32:33], v233 offset:6144
  v_exp_f32 v100, v100
  s_setprio 1
  v_exp_f32 v101, v101
  v_exp_f32 v102, v102
  v_exp_f32 v103, v103
  s_waitcnt lgkmcnt(0)
  v_mfma_f32_32x32x8_bf16 v[56:71], v[32:33], v[228:229], 0
  s_mov_b32 m0, s53
  v_exp_f32 v104, v104
  v_exp_f32 v105, v105
  v_exp_f32 v106, v106
  v_exp_f32 v107, v107
  v_mfma_f32_32x32x16_bf16 v[56:71], v[28:31], v[16:19], v[56:71]
  ds_read_b128 v[120:123], v234 offset:6144
  ds_read_b128 v[124:127], v234 offset:6912
  v_exp_f32 v108, v108
  v_exp_f32 v109, v109
  v_exp_f32 v110, v110
  v_exp_f32 v111, v111
  v_smfmac_f32_32x32x32_bf16 v[196:211], v[128:131], v[88:95], v5
  buffer_load_dwordx4 v136, s[32:35], s52 offen offset:0 lds
  v_exp_f32 v112, v112
  v_exp_f32 v113, v113
  v_exp_f32 v114, v114
  v_exp_f32 v115, v115
  v_smfmac_f32_32x32x32_bf16 v[196:211], v[132:135], v[96:103], v5
  v_exp_f32 v116, v116
  v_exp_f32 v117, v117
  v_exp_f32 v118, v118
  v_exp_f32 v119, v119
  v_mfma_f32_32x32x8_bf16 v[72:87], v[32:33], v[230:231], 0
  v_exp_f32 v56, v56
  v_exp_f32 v57, v57
  v_exp_f32 v58, v58
  v_exp_f32 v59, v59
  v_mfma_f32_32x32x16_bf16 v[72:87], v[28:31], v[20:23], v[72:87]
  v_exp_f32 v60, v60
  v_exp_f32 v61, v61
  v_exp_f32 v62, v62
  v_exp_f32 v63, v63
  v_smfmac_f32_32x32x32_bf16 v[212:227], v[128:131], v[104:111], v5
  buffer_load_dwordx4 v137, s[32:35], s52 offen offset:1024 lds
  v_exp_f32 v64, v64
  v_exp_f32 v65, v65
  v_exp_f32 v66, v66
  v_exp_f32 v67, v67
  v_smfmac_f32_32x32x32_bf16 v[212:227], v[132:135], v[112:119], v5
  ds_read_b128 v[28:31], v232 offset:9216
  ds_read_b64 v[32:33], v233 offset:9216
  v_exp_f32 v68, v68
  s_setprio 0
  v_exp_f32 v69, v69
  v_exp_f32 v70, v70
  v_exp_f32 v71, v71
  s_waitcnt lgkmcnt(0)
  v_mfma_f32_32x32x8_bf16 v[88:103], v[32:33], v[228:229], 0
  v_exp_f32 v72, v72
  v_exp_f32 v73, v73
  v_exp_f32 v74, v74
  v_exp_f32 v75, v75
  v_mfma_f32_32x32x16_bf16 v[88:103], v[28:31], v[16:19], v[88:103]
  ds_read_b128 v[128:131], v234 offset:9216
  ds_read_b128 v[132:135], v234 offset:9984
  v_exp_f32 v76, v76
  v_exp_f32 v77, v77
  v_exp_f32 v78, v78
  v_exp_f32 v79, v79
  v_smfmac_f32_32x32x32_bf16 v[196:211], v[120:123], v[56:63], v5
  buffer_load_dwordx4 v138, s[32:35], s52 offen offset:2048 lds
  v_exp_f32 v80, v80
  v_exp_f32 v81, v81
  v_exp_f32 v82, v82
  v_exp_f32 v83, v83
  v_smfmac_f32_32x32x32_bf16 v[196:211], v[124:127], v[64:71], v5
  v_exp_f32 v84, v84
  v_exp_f32 v85, v85
  v_exp_f32 v86, v86
  v_exp_f32 v87, v87
  v_mfma_f32_32x32x8_bf16 v[104:119], v[32:33], v[230:231], 0
  v_exp_f32 v88, v88
  v_exp_f32 v89, v89
  v_exp_f32 v90, v90
  s_waitcnt vmcnt(3) lgkmcnt(0)
  s_barrier
  s_setprio 3
  v_exp_f32 v91, v91
  v_mfma_f32_32x32x16_bf16 v[104:119], v[28:31], v[20:23], v[104:119]
  ds_read_b128 v[28:31], v232 offset:26112
  ds_read_b64 v[32:33], v233 offset:26112
  v_exp_f32 v92, v92
  v_exp_f32 v93, v93
  v_exp_f32 v94, v94
  v_exp_f32 v95, v95
  v_smfmac_f32_32x32x32_bf16 v[212:227], v[120:123], v[72:79], v5
  v_exp_f32 v96, v96
  v_exp_f32 v97, v97
  v_exp_f32 v98, v98
  v_exp_f32 v99, v99
  v_smfmac_f32_32x32x32_bf16 v[212:227], v[124:127], v[80:87], v5
  v_exp_f32 v100, v100
  v_exp_f32 v101, v101
  v_exp_f32 v102, v102
  v_exp_f32 v103, v103
  s_waitcnt lgkmcnt(0)
  v_mfma_f32_32x32x8_bf16 v[56:71], v[32:33], v[228:229], 0
  v_exp_f32 v104, v104
  v_exp_f32 v105, v105
  v_exp_f32 v106, v106
  v_exp_f32 v107, v107
  v_mfma_f32_32x32x16_bf16 v[56:71], v[28:31], v[16:19], v[56:71]
  ds_read_b128 v[120:123], v234 offset:26112
  ds_read_b128 v[124:127], v234 offset:26880
  v_exp_f32 v108, v108
  v_exp_f32 v109, v109
  v_exp_f32 v110, v110
  v_exp_f32 v111, v111
  v_smfmac_f32_32x32x32_bf16 v[196:211], v[128:131], v[88:95], v5
  buffer_load_dwordx4 v139, s[32:35], s52 offen offset:3072 lds
  v_exp_f32 v112, v112
  v_exp_f32 v113, v113
  v_exp_f32 v114, v114
  v_exp_f32 v115, v115
  v_smfmac_f32_32x32x32_bf16 v[196:211], v[132:135], v[96:103], v5
  v_exp_f32 v116, v116
  v_exp_f32 v117, v117
  v_exp_f32 v118, v118
  v_exp_f32 v119, v119
  v_mfma_f32_32x32x8_bf16 v[72:87], v[32:33], v[230:231], 0
  v_exp_f32 v56, v56
  v_exp_f32 v57, v57
  v_exp_f32 v58, v58
  v_exp_f32 v59, v59
  v_mfma_f32_32x32x16_bf16 v[72:87], v[28:31], v[20:23], v[72:87]
  s_xor_b32 s51, s51, 229376
  s_add_u32 m0, s50, 102400
  v_exp_f32 v60, v60
  v_exp_f32 v61, v61
  v_exp_f32 v62, v62
  v_exp_f32 v63, v63
  v_smfmac_f32_32x32x32_bf16 v[212:227], v[128:131], v[104:111], v5
  buffer_load_dwordx4 v6, s[40:43], s51 offen offset:0 sc1 lds
  v_exp_f32 v64, v64
  v_exp_f32 v65, v65
  v_exp_f32 v66, v66
  v_exp_f32 v67, v67
  v_smfmac_f32_32x32x32_bf16 v[212:227], v[132:135], v[112:119], v5
  ds_read_b128 v[28:31], v232 offset:29184
  ds_read_b64 v[32:33], v233 offset:29184
  v_exp_f32 v68, v68
  s_setprio 2
  v_exp_f32 v69, v69
  v_exp_f32 v70, v70
  v_exp_f32 v71, v71
  s_waitcnt lgkmcnt(0)
  v_mfma_f32_32x32x8_bf16 v[88:103], v[32:33], v[228:229], 0
  v_exp_f32 v72, v72
  v_exp_f32 v73, v73
  v_exp_f32 v74, v74
  v_exp_f32 v75, v75
  v_mfma_f32_32x32x16_bf16 v[88:103], v[28:31], v[16:19], v[88:103]
  ds_read_b128 v[128:131], v234 offset:29184
  ds_read_b128 v[132:135], v234 offset:29952
  v_exp_f32 v76, v76
  v_exp_f32 v77, v77
  v_exp_f32 v78, v78
  v_exp_f32 v79, v79
  v_smfmac_f32_32x32x32_bf16 v[196:211], v[120:123], v[56:63], v5
  buffer_load_dwordx4 v6, s[40:43], s51 offen offset:1024 sc1 lds
  v_exp_f32 v80, v80
  v_exp_f32 v81, v81
  v_exp_f32 v82, v82
  v_exp_f32 v83, v83
  v_smfmac_f32_32x32x32_bf16 v[196:211], v[124:127], v[64:71], v5
  v_exp_f32 v84, v84
  v_exp_f32 v85, v85
  v_exp_f32 v86, v86
  v_exp_f32 v87, v87
  v_mfma_f32_32x32x8_bf16 v[104:119], v[32:33], v[230:231], 0
  v_exp_f32 v88, v88
  v_exp_f32 v89, v89
  v_exp_f32 v90, v90
  v_exp_f32 v91, v91
  v_mfma_f32_32x32x16_bf16 v[104:119], v[28:31], v[20:23], v[104:119]
  v_exp_f32 v92, v92
  v_exp_f32 v93, v93
  v_exp_f32 v94, v94
  v_exp_f32 v95, v95
  v_smfmac_f32_32x32x32_bf16 v[212:227], v[120:123], v[72:79], v5
  buffer_load_dwordx4 v6, s[40:43], s51 offen offset:2048 sc1 lds
  v_exp_f32 v96, v96
  v_exp_f32 v97, v97
  v_exp_f32 v98, v98
  v_exp_f32 v99, v99
  v_smfmac_f32_32x32x32_bf16 v[212:227], v[124:127], v[80:87], v5
  ds_read_b128 v[28:31], v232 offset:32256
  ds_read_b64 v[32:33], v233 offset:32256
  v_exp_f32 v100, v100
  s_setprio 1
  v_exp_f32 v101, v101
  v_exp_f32 v102, v102
  v_exp_f32 v103, v103
  s_waitcnt lgkmcnt(0)
  v_mfma_f32_32x32x8_bf16 v[56:71], v[32:33], v[228:229], 0
  s_mov_b32 m0, s55
  v_exp_f32 v104, v104
  v_exp_f32 v105, v105
  v_exp_f32 v106, v106
  v_exp_f32 v107, v107
  v_mfma_f32_32x32x16_bf16 v[56:71], v[28:31], v[16:19], v[56:71]
  ds_read_b128 v[120:123], v234 offset:32256
  ds_read_b128 v[124:127], v234 offset:33024
  v_exp_f32 v108, v108
  v_exp_f32 v109, v109
  v_exp_f32 v110, v110
  v_exp_f32 v111, v111
  v_smfmac_f32_32x32x32_bf16 v[196:211], v[128:131], v[88:95], v5
  buffer_load_dwordx4 v136, s[32:35], s54 offen offset:0 lds
  v_exp_f32 v112, v112
  v_exp_f32 v113, v113
  v_exp_f32 v114, v114
  v_exp_f32 v115, v115
  v_smfmac_f32_32x32x32_bf16 v[196:211], v[132:135], v[96:103], v5
  v_exp_f32 v116, v116
  v_exp_f32 v117, v117
  v_exp_f32 v118, v118
  v_exp_f32 v119, v119
  v_mfma_f32_32x32x8_bf16 v[72:87], v[32:33], v[230:231], 0
  v_exp_f32 v56, v56
  v_exp_f32 v57, v57
  v_exp_f32 v58, v58
  v_exp_f32 v59, v59
  v_mfma_f32_32x32x16_bf16 v[72:87], v[28:31], v[20:23], v[72:87]
  v_exp_f32 v60, v60
  v_exp_f32 v61, v61
  v_exp_f32 v62, v62
  v_exp_f32 v63, v63
  v_smfmac_f32_32x32x32_bf16 v[212:227], v[128:131], v[104:111], v5
  buffer_load_dwordx4 v137, s[32:35], s54 offen offset:1024 lds
  v_exp_f32 v64, v64
  v_exp_f32 v65, v65
  v_exp_f32 v66, v66
  v_exp_f32 v67, v67
  v_smfmac_f32_32x32x32_bf16 v[212:227], v[132:135], v[112:119], v5
  ds_read_b128 v[28:31], v232 offset:35328
  ds_read_b64 v[32:33], v233 offset:35328
  v_exp_f32 v68, v68
  s_setprio 0
  v_exp_f32 v69, v69
  v_exp_f32 v70, v70
  v_exp_f32 v71, v71
  s_waitcnt lgkmcnt(0)
  v_mfma_f32_32x32x8_bf16 v[88:103], v[32:33], v[228:229], 0
  v_exp_f32 v72, v72
  v_exp_f32 v73, v73
  v_exp_f32 v74, v74
  v_exp_f32 v75, v75
  v_mfma_f32_32x32x16_bf16 v[88:103], v[28:31], v[16:19], v[88:103]
  ds_read_b128 v[128:131], v234 offset:35328
  ds_read_b128 v[132:135], v234 offset:36096
  v_exp_f32 v76, v76
  v_exp_f32 v77, v77
  v_exp_f32 v78, v78
  v_exp_f32 v79, v79
  v_smfmac_f32_32x32x32_bf16 v[196:211], v[120:123], v[56:63], v5
  buffer_load_dwordx4 v138, s[32:35], s54 offen offset:2048 lds
  v_exp_f32 v80, v80
  v_exp_f32 v81, v81
  v_exp_f32 v82, v82
  v_exp_f32 v83, v83
  v_smfmac_f32_32x32x32_bf16 v[196:211], v[124:127], v[64:71], v5
  v_exp_f32 v84, v84
  v_exp_f32 v85, v85
  v_exp_f32 v86, v86
  v_exp_f32 v87, v87
  v_mfma_f32_32x32x8_bf16 v[104:119], v[32:33], v[230:231], 0
  v_exp_f32 v88, v88
  v_exp_f32 v89, v89
  v_exp_f32 v90, v90
  s_waitcnt vmcnt(3) lgkmcnt(0)
  s_barrier
  s_setprio 3
  v_exp_f32 v91, v91
  v_mfma_f32_32x32x16_bf16 v[104:119], v[28:31], v[20:23], v[104:119]
  ds_read_b128 v[28:31], v232 offset:0
  ds_read_b64 v[32:33], v233 offset:0
  v_exp_f32 v92, v92
  v_exp_f32 v93, v93
  v_exp_f32 v94, v94
  v_exp_f32 v95, v95
  v_smfmac_f32_32x32x32_bf16 v[212:227], v[120:123], v[72:79], v5
  v_exp_f32 v96, v96
  v_exp_f32 v97, v97
  v_exp_f32 v98, v98
  v_exp_f32 v99, v99
  v_smfmac_f32_32x32x32_bf16 v[212:227], v[124:127], v[80:87], v5
  v_exp_f32 v100, v100
  v_exp_f32 v101, v101
  v_exp_f32 v102, v102
  v_exp_f32 v103, v103
  s_waitcnt lgkmcnt(0)
  v_mfma_f32_32x32x8_bf16 v[56:71], v[32:33], v[228:229], 0
  v_exp_f32 v104, v104
  v_exp_f32 v105, v105
  v_exp_f32 v106, v106
  v_exp_f32 v107, v107
  v_mfma_f32_32x32x16_bf16 v[56:71], v[28:31], v[16:19], v[56:71]
  ds_read_b128 v[120:123], v234 offset:0
  ds_read_b128 v[124:127], v234 offset:768
  v_exp_f32 v108, v108
  v_exp_f32 v109, v109
  v_exp_f32 v110, v110
  v_exp_f32 v111, v111
  v_smfmac_f32_32x32x32_bf16 v[196:211], v[128:131], v[88:95], v5
  buffer_load_dwordx4 v139, s[32:35], s54 offen offset:3072 lds
  v_exp_f32 v112, v112
  v_exp_f32 v113, v113
  v_exp_f32 v114, v114
  v_exp_f32 v115, v115
  v_smfmac_f32_32x32x32_bf16 v[196:211], v[132:135], v[96:103], v5
  v_exp_f32 v116, v116
  v_exp_f32 v117, v117
  v_exp_f32 v118, v118
  v_exp_f32 v119, v119
  v_mfma_f32_32x32x8_bf16 v[72:87], v[32:33], v[230:231], 0
  v_exp_f32 v56, v56
  v_exp_f32 v57, v57
  v_exp_f32 v58, v58
  v_exp_f32 v59, v59
  v_mfma_f32_32x32x16_bf16 v[72:87], v[28:31], v[20:23], v[72:87]
  s_xor_b32 s51, s51, 32768
  s_add_u32 m0, s50, 128512
  v_exp_f32 v60, v60
  v_exp_f32 v61, v61
  v_exp_f32 v62, v62
  v_exp_f32 v63, v63
  v_smfmac_f32_32x32x32_bf16 v[212:227], v[128:131], v[104:111], v5
  buffer_load_dwordx4 v6, s[40:43], s51 offen offset:0 sc1 lds
  v_exp_f32 v64, v64
  v_exp_f32 v65, v65
  v_exp_f32 v66, v66
  v_exp_f32 v67, v67
  v_smfmac_f32_32x32x32_bf16 v[212:227], v[132:135], v[112:119], v5
  ds_read_b128 v[28:31], v232 offset:3072
  ds_read_b64 v[32:33], v233 offset:3072
  v_exp_f32 v68, v68
  s_setprio 2
  v_exp_f32 v69, v69
  v_exp_f32 v70, v70
  v_exp_f32 v71, v71
  s_waitcnt lgkmcnt(0)
  v_mfma_f32_32x32x8_bf16 v[88:103], v[32:33], v[228:229], 0
  v_exp_f32 v72, v72
  v_exp_f32 v73, v73
  v_exp_f32 v74, v74
  v_exp_f32 v75, v75
  v_mfma_f32_32x32x16_bf16 v[88:103], v[28:31], v[16:19], v[88:103]
  ds_read_b128 v[128:131], v234 offset:3072
  ds_read_b128 v[132:135], v234 offset:3840
  v_exp_f32 v76, v76
  v_exp_f32 v77, v77
  v_exp_f32 v78, v78
  v_exp_f32 v79, v79
  v_smfmac_f32_32x32x32_bf16 v[196:211], v[120:123], v[56:63], v5
  buffer_load_dwordx4 v6, s[40:43], s51 offen offset:1024 sc1 lds
  v_exp_f32 v80, v80
  v_exp_f32 v81, v81
  v_exp_f32 v82, v82
  v_exp_f32 v83, v83
  v_smfmac_f32_32x32x32_bf16 v[196:211], v[124:127], v[64:71], v5
  v_exp_f32 v84, v84
  v_exp_f32 v85, v85
  v_exp_f32 v86, v86
  v_exp_f32 v87, v87
  v_mfma_f32_32x32x8_bf16 v[104:119], v[32:33], v[230:231], 0
  v_exp_f32 v88, v88
  v_exp_f32 v89, v89
  v_exp_f32 v90, v90
  v_exp_f32 v91, v91
  v_mfma_f32_32x32x16_bf16 v[104:119], v[28:31], v[20:23], v[104:119]
  v_exp_f32 v92, v92
  v_exp_f32 v93, v93
  v_exp_f32 v94, v94
  v_exp_f32 v95, v95
  v_smfmac_f32_32x32x32_bf16 v[212:227], v[120:123], v[72:79], v5
  buffer_load_dwordx4 v6, s[40:43], s51 offen offset:2048 sc1 lds
  v_exp_f32 v96, v96
  v_exp_f32 v97, v97
  v_exp_f32 v98, v98
  v_exp_f32 v99, v99
  v_smfmac_f32_32x32x32_bf16 v[212:227], v[124:127], v[80:87], v5
  ds_read_b128 v[28:31], v232 offset:6144
  ds_read_b64 v[32:33], v233 offset:6144
  v_exp_f32 v100, v100
  s_setprio 1
  v_exp_f32 v101, v101
  v_exp_f32 v102, v102
  v_exp_f32 v103, v103
  s_waitcnt lgkmcnt(0)
  v_mfma_f32_32x32x8_bf16 v[56:71], v[32:33], v[228:229], 0
  s_mov_b32 m0, s57
  v_exp_f32 v104, v104
  v_exp_f32 v105, v105
  v_exp_f32 v106, v106
  v_exp_f32 v107, v107
  v_mfma_f32_32x32x16_bf16 v[56:71], v[28:31], v[16:19], v[56:71]
  ds_read_b128 v[120:123], v234 offset:6144
  ds_read_b128 v[124:127], v234 offset:6912
  v_exp_f32 v108, v108
  v_exp_f32 v109, v109
  v_exp_f32 v110, v110
  v_exp_f32 v111, v111
  v_smfmac_f32_32x32x32_bf16 v[196:211], v[128:131], v[88:95], v5
  buffer_load_dwordx4 v141, s[32:35], s56 offen offset:0 lds
  v_exp_f32 v112, v112
  v_exp_f32 v113, v113
  v_exp_f32 v114, v114
  v_exp_f32 v115, v115
  v_smfmac_f32_32x32x32_bf16 v[196:211], v[132:135], v[96:103], v5
  v_exp_f32 v116, v116
  v_exp_f32 v117, v117
  v_exp_f32 v118, v118
  v_exp_f32 v119, v119
  v_mfma_f32_32x32x8_bf16 v[72:87], v[32:33], v[230:231], 0
  v_exp_f32 v56, v56
  v_exp_f32 v57, v57
  v_exp_f32 v58, v58
  v_exp_f32 v59, v59
  v_mfma_f32_32x32x16_bf16 v[72:87], v[28:31], v[20:23], v[72:87]
  v_exp_f32 v60, v60
  v_exp_f32 v61, v61
  v_exp_f32 v62, v62
  v_exp_f32 v63, v63
  v_smfmac_f32_32x32x32_bf16 v[212:227], v[128:131], v[104:111], v5
  buffer_load_dwordx4 v142, s[32:35], s56 offen offset:1024 lds
  v_exp_f32 v64, v64
  v_exp_f32 v65, v65
  v_exp_f32 v66, v66
  v_exp_f32 v67, v67
  v_smfmac_f32_32x32x32_bf16 v[212:227], v[132:135], v[112:119], v5
  ds_read_b128 v[28:31], v232 offset:9216
  ds_read_b64 v[32:33], v233 offset:9216
  v_exp_f32 v68, v68
  s_setprio 0
  v_exp_f32 v69, v69
  v_exp_f32 v70, v70
  v_exp_f32 v71, v71
  s_waitcnt lgkmcnt(0)
  v_mfma_f32_32x32x8_bf16 v[88:103], v[32:33], v[228:229], 0
  v_exp_f32 v72, v72
  v_exp_f32 v73, v73
  v_exp_f32 v74, v74
  v_exp_f32 v75, v75
  v_mfma_f32_32x32x16_bf16 v[88:103], v[28:31], v[16:19], v[88:103]
  ds_read_b128 v[128:131], v234 offset:9216
  ds_read_b128 v[132:135], v234 offset:9984
  v_exp_f32 v76, v76
  v_exp_f32 v77, v77
  v_exp_f32 v78, v78
  v_exp_f32 v79, v79
  v_smfmac_f32_32x32x32_bf16 v[196:211], v[120:123], v[56:63], v5
  buffer_load_dwordx4 v143, s[32:35], s56 offen offset:2048 lds
  v_exp_f32 v80, v80
  v_exp_f32 v81, v81
  v_exp_f32 v82, v82
  v_exp_f32 v83, v83
  v_smfmac_f32_32x32x32_bf16 v[196:211], v[124:127], v[64:71], v5
  v_exp_f32 v84, v84
  v_exp_f32 v85, v85
  v_exp_f32 v86, v86
  v_exp_f32 v87, v87
  v_mfma_f32_32x32x8_bf16 v[104:119], v[32:33], v[230:231], 0
  v_exp_f32 v88, v88
  v_exp_f32 v89, v89
  v_exp_f32 v90, v90
  s_waitcnt vmcnt(3) lgkmcnt(0)
  s_barrier
  s_setprio 3
  v_exp_f32 v91, v91
  v_mfma_f32_32x32x16_bf16 v[104:119], v[28:31], v[20:23], v[104:119]
  ds_read_b128 v[28:31], v232 offset:26112
  ds_read_b64 v[32:33], v233 offset:26112
  v_exp_f32 v92, v92
  v_exp_f32 v93, v93
  v_exp_f32 v94, v94
  v_exp_f32 v95, v95
  v_smfmac_f32_32x32x32_bf16 v[212:227], v[120:123], v[72:79], v5
  v_exp_f32 v96, v96
  v_exp_f32 v97, v97
  v_exp_f32 v98, v98
  v_exp_f32 v99, v99
  v_smfmac_f32_32x32x32_bf16 v[212:227], v[124:127], v[80:87], v5
  v_exp_f32 v100, v100
  v_exp_f32 v101, v101
  v_exp_f32 v102, v102
  v_exp_f32 v103, v103
  s_waitcnt lgkmcnt(0)
  v_mfma_f32_32x32x8_bf16 v[56:71], v[32:33], v[228:229], 0
  v_exp_f32 v104, v104
  v_exp_f32 v105, v105
  v_exp_f32 v106, v106
  s_add_u32 m0, s53, 4096
  v_exp_f32 v107, v107
  v_mfma_f32_32x32x16_bf16 v[56:71], v[28:31], v[16:19], v[56:71]
  ds_read_b128 v[120:123], v234 offset:26112
  ds_read_b128 v[124:127], v234 offset:26880
  v_exp_f32 v108, v108
  v_exp_f32 v109, v109
  v_exp_f32 v110, v110
  v_exp_f32 v111, v111
  v_smfmac_f32_32x32x32_bf16 v[196:211], v[128:131], v[88:95], v5
  buffer_load_dwordx4 v140, s[32:35], s52 offen offset:0 lds
  v_exp_f32 v112, v112
  v_exp_f32 v113, v113
  v_exp_f32 v114, v114
  v_exp_f32 v115, v115
  v_smfmac_f32_32x32x32_bf16 v[196:211], v[132:135], v[96:103], v5
  v_exp_f32 v116, v116
  v_exp_f32 v117, v117
  v_exp_f32 v118, v118
  v_exp_f32 v119, v119
  v_mfma_f32_32x32x8_bf16 v[72:87], v[32:33], v[230:231], 0
  v_exp_f32 v56, v56
  v_exp_f32 v57, v57
  v_exp_f32 v58, v58
  v_exp_f32 v59, v59
  v_mfma_f32_32x32x16_bf16 v[72:87], v[28:31], v[20:23], v[72:87]
  s_xor_b32 s51, s51, 98304
  s_add_u32 m0, s50, 102400
  v_exp_f32 v60, v60
  v_exp_f32 v61, v61
  v_exp_f32 v62, v62
  v_exp_f32 v63, v63
  v_smfmac_f32_32x32x32_bf16 v[212:227], v[128:131], v[104:111], v5
  buffer_load_dwordx4 v6, s[40:43], s51 offen offset:0 sc1 lds
  v_exp_f32 v64, v64
  v_exp_f32 v65, v65
  v_exp_f32 v66, v66
  v_exp_f32 v67, v67
  v_smfmac_f32_32x32x32_bf16 v[212:227], v[132:135], v[112:119], v5
  ds_read_b128 v[28:31], v232 offset:29184
  ds_read_b64 v[32:33], v233 offset:29184
  v_exp_f32 v68, v68
  s_setprio 2
  v_exp_f32 v69, v69
  v_exp_f32 v70, v70
  v_exp_f32 v71, v71
  s_waitcnt lgkmcnt(0)
  v_mfma_f32_32x32x8_bf16 v[88:103], v[32:33], v[228:229], 0
  v_exp_f32 v72, v72
  v_exp_f32 v73, v73
  v_exp_f32 v74, v74
  v_exp_f32 v75, v75
  v_mfma_f32_32x32x16_bf16 v[88:103], v[28:31], v[16:19], v[88:103]
  ds_read_b128 v[128:131], v234 offset:29184
  ds_read_b128 v[132:135], v234 offset:29952
  v_exp_f32 v76, v76
  v_exp_f32 v77, v77
  v_exp_f32 v78, v78
  v_exp_f32 v79, v79
  v_smfmac_f32_32x32x32_bf16 v[196:211], v[120:123], v[56:63], v5
  buffer_load_dwordx4 v6, s[40:43], s51 offen offset:1024 sc1 lds
  v_exp_f32 v80, v80
  v_exp_f32 v81, v81
  v_exp_f32 v82, v82
  v_exp_f32 v83, v83
  v_smfmac_f32_32x32x32_bf16 v[196:211], v[124:127], v[64:71], v5
  v_exp_f32 v84, v84
  v_exp_f32 v85, v85
  v_exp_f32 v86, v86
  v_exp_f32 v87, v87
  v_mfma_f32_32x32x8_bf16 v[104:119], v[32:33], v[230:231], 0
  v_exp_f32 v88, v88
  v_exp_f32 v89, v89
  v_exp_f32 v90, v90
  v_exp_f32 v91, v91
  v_mfma_f32_32x32x16_bf16 v[104:119], v[28:31], v[20:23], v[104:119]
  v_exp_f32 v92, v92
  v_exp_f32 v93, v93
  v_exp_f32 v94, v94
  v_exp_f32 v95, v95
  v_smfmac_f32_32x32x32_bf16 v[212:227], v[120:123], v[72:79], v5
  buffer_load_dwordx4 v6, s[40:43], s51 offen offset:2048 sc1 lds
  v_exp_f32 v96, v96
  v_exp_f32 v97, v97
  v_exp_f32 v98, v98
  v_exp_f32 v99, v99
  v_smfmac_f32_32x32x32_bf16 v[212:227], v[124:127], v[80:87], v5
  ds_read_b128 v[28:31], v232 offset:32256
  ds_read_b64 v[32:33], v233 offset:32256
  v_exp_f32 v100, v100
  s_setprio 1
  v_exp_f32 v101, v101
  v_exp_f32 v102, v102
  v_exp_f32 v103, v103
  s_waitcnt lgkmcnt(0)
  v_mfma_f32_32x32x8_bf16 v[56:71], v[32:33], v[228:229], 0
  s_add_u32 m0, s55, 4096
  v_exp_f32 v104, v104
  v_exp_f32 v105, v105
  v_exp_f32 v106, v106
  v_exp_f32 v107, v107
  v_mfma_f32_32x32x16_bf16 v[56:71], v[28:31], v[16:19], v[56:71]
  ds_read_b128 v[120:123], v234 offset:32256
  ds_read_b128 v[124:127], v234 offset:33024
  v_exp_f32 v108, v108
  v_exp_f32 v109, v109
  v_exp_f32 v110, v110
  v_exp_f32 v111, v111
  v_smfmac_f32_32x32x32_bf16 v[196:211], v[128:131], v[88:95], v5
  buffer_load_dwordx4 v140, s[32:35], s54 offen offset:0 lds
  v_exp_f32 v112, v112
  v_exp_f32 v113, v113
  v_exp_f32 v114, v114
  v_exp_f32 v115, v115
  v_smfmac_f32_32x32x32_bf16 v[196:211], v[132:135], v[96:103], v5
  v_exp_f32 v116, v116
  v_exp_f32 v117, v117
  v_exp_f32 v118, v118
  v_exp_f32 v119, v119
  v_mfma_f32_32x32x8_bf16 v[72:87], v[32:33], v[230:231], 0
  v_exp_f32 v56, v56
  v_exp_f32 v57, v57
  v_exp_f32 v58, v58
  v_exp_f32 v59, v59
  v_mfma_f32_32x32x16_bf16 v[72:87], v[28:31], v[20:23], v[72:87]
  s_mov_b32 s27, 278528
  v_exp_f32 v60, v60
  v_exp_f32 v61, v61
  v_exp_f32 v62, v62
  v_exp_f32 v63, v63
  v_smfmac_f32_32x32x32_bf16 v[212:227], v[128:131], v[104:111], v5
  buffer_load_dword v148, v146, s[40:43], s27 offen sc1
  v_exp_f32 v64, v64
  v_exp_f32 v65, v65
  v_exp_f32 v66, v66
  v_exp_f32 v67, v67
  v_smfmac_f32_32x32x32_bf16 v[212:227], v[132:135], v[112:119], v5
  ds_read_b128 v[28:31], v232 offset:35328
  ds_read_b64 v[32:33], v233 offset:35328
  v_exp_f32 v68, v68
  s_setprio 0
  v_exp_f32 v69, v69
  v_exp_f32 v70, v70
  v_exp_f32 v71, v71
  s_waitcnt lgkmcnt(0)
  v_mfma_f32_32x32x8_bf16 v[88:103], v[32:33], v[228:229], 0
  v_exp_f32 v72, v72
  v_exp_f32 v73, v73
  v_exp_f32 v74, v74
  v_exp_f32 v75, v75
  v_mfma_f32_32x32x16_bf16 v[88:103], v[28:31], v[16:19], v[88:103]
  ds_read_b128 v[128:131], v234 offset:35328
  ds_read_b128 v[132:135], v234 offset:36096
  v_exp_f32 v76, v76
  v_exp_f32 v77, v77
  v_exp_f32 v78, v78
  v_exp_f32 v79, v79
  v_smfmac_f32_32x32x32_bf16 v[196:211], v[120:123], v[56:63], v5
  v_exp_f32 v80, v80
  v_exp_f32 v81, v81
  v_exp_f32 v82, v82
  v_exp_f32 v83, v83
  v_smfmac_f32_32x32x32_bf16 v[196:211], v[124:127], v[64:71], v5
  v_exp_f32 v84, v84
  v_exp_f32 v85, v85
  v_exp_f32 v86, v86
  v_exp_f32 v87, v87
  v_mfma_f32_32x32x8_bf16 v[104:119], v[32:33], v[230:231], 0
  v_exp_f32 v88, v88
  v_exp_f32 v89, v89
  v_exp_f32 v90, v90
  s_waitcnt vmcnt(1) lgkmcnt(0)
  s_barrier
  s_setprio 3
  v_exp_f32 v91, v91
  v_mfma_f32_32x32x16_bf16 v[104:119], v[28:31], v[20:23], v[104:119]
  ds_read_b128 v[28:31], v232 offset:0
  ds_read_b64 v[32:33], v233 offset:0
  v_exp_f32_e64 v92, v92
  v_exp_f32_e64 v93, v93
  v_exp_f32_e64 v94, v94
  v_exp_f32_e64 v95, v95
  v_smfmac_f32_32x32x32_bf16 v[212:227], v[120:123], v[72:79], v5
  v_exp_f32 v96, v96
  v_exp_f32 v97, v97
  v_exp_f32 v98, v98
  v_exp_f32 v99, v99
  v_smfmac_f32_32x32x32_bf16 v[212:227], v[124:127], v[80:87], v5
  v_exp_f32 v100, v100
  v_exp_f32 v101, v101
  v_exp_f32 v102, v102
  v_exp_f32 v103, v103
  s_waitcnt lgkmcnt(0)
  v_mfma_f32_32x32x8_bf16 v[56:71], v[32:33], v[228:229], 0
  v_exp_f32 v104, v104
  v_exp_f32 v105, v105
  v_exp_f32 v106, v106
  v_exp_f32 v107, v107
  v_mfma_f32_32x32x16_bf16 v[56:71], v[28:31], v[16:19], v[56:71]
  ds_read_b128 v[120:123], v234 offset:0
  ds_read_b128 v[124:127], v234 offset:768
  v_exp_f32 v108, v108
  v_exp_f32 v109, v109
  v_exp_f32 v110, v110
  v_exp_f32 v111, v111
  v_smfmac_f32_32x32x32_bf16 v[196:211], v[128:131], v[88:95], v5
  v_exp_f32 v112, v112
  v_exp_f32 v113, v113
  v_exp_f32 v114, v114
  v_exp_f32 v115, v115
  v_smfmac_f32_32x32x32_bf16 v[196:211], v[132:135], v[96:103], v5
  v_exp_f32 v116, v116
  v_exp_f32 v117, v117
  v_exp_f32 v118, v118
  v_exp_f32 v119, v119
  v_mfma_f32_32x32x8_bf16 v[72:87], v[32:33], v[230:231], 0
  v_exp_f32 v56, v56
  v_exp_f32 v57, v57
  v_exp_f32 v58, v58
  v_exp_f32 v59, v59
  v_mfma_f32_32x32x16_bf16 v[72:87], v[28:31], v[20:23], v[72:87]
  s_xor_b32 s51, s51, 32768
  s_add_u32 m0, s50, 128512
  v_exp_f32 v60, v60
  v_exp_f32 v61, v61
  v_exp_f32 v62, v62
  v_exp_f32 v63, v63
  v_smfmac_f32_32x32x32_bf16 v[212:227], v[128:131], v[104:111], v5
  buffer_load_dwordx4 v6, s[40:43], s51 offen offset:0 sc1 lds
  v_exp_f32 v64, v64
  v_exp_f32 v65, v65
  v_exp_f32 v66, v66
  v_exp_f32 v67, v67
  v_smfmac_f32_32x32x32_bf16 v[212:227], v[132:135], v[112:119], v5
  ds_read_b128 v[28:31], v232 offset:3072
  ds_read_b64 v[32:33], v233 offset:3072
  v_exp_f32 v68, v68
  s_setprio 2
  v_exp_f32 v69, v69
  v_exp_f32 v70, v70
  v_exp_f32 v71, v71
  s_waitcnt lgkmcnt(0)
  v_mfma_f32_32x32x8_bf16 v[88:103], v[32:33], v[228:229], 0
  v_exp_f32 v72, v72
  v_exp_f32 v73, v73
  v_exp_f32 v74, v74
  v_exp_f32 v75, v75
  v_mfma_f32_32x32x16_bf16 v[88:103], v[28:31], v[16:19], v[88:103]
  ds_read_b128 v[128:131], v234 offset:3072
  ds_read_b128 v[132:135], v234 offset:3840
  ds_read_b64_tr_b16 v[156:157], v239 offset:0
  ds_read_b64_tr_b16 v[158:159], v240 offset:0
  v_exp_f32 v76, v76
  v_exp_f32 v77, v77
  v_exp_f32 v78, v78
  v_exp_f32 v79, v79
  v_smfmac_f32_32x32x32_bf16 v[196:211], v[120:123], v[56:63], v5
  buffer_load_dwordx4 v6, s[40:43], s51 offen offset:1024 sc1 lds
  v_exp_f32 v80, v80
  v_exp_f32 v81, v81
  v_exp_f32 v82, v82
  v_exp_f32 v83, v83
  v_smfmac_f32_32x32x32_bf16 v[196:211], v[124:127], v[64:71], v5
  ds_read_b64_tr_b16 v[160:161], v239 offset:8
  ds_read_b64_tr_b16 v[162:163], v240 offset:8
  v_exp_f32 v84, v84
  v_exp_f32 v85, v85
  v_exp_f32 v86, v86
  v_exp_f32 v87, v87
  v_mfma_f32_32x32x8_bf16 v[104:119], v[32:33], v[230:231], 0
  v_exp_f32 v88, v88
  v_exp_f32 v89, v89
  v_exp_f32 v90, v90
  v_exp_f32 v91, v91
  v_mfma_f32_32x32x16_bf16 v[104:119], v[28:31], v[20:23], v[104:119]
  v_exp_f32 v92, v92
  v_exp_f32 v93, v93
  v_exp_f32 v94, v94
  v_exp_f32 v95, v95
  v_smfmac_f32_32x32x32_bf16 v[212:227], v[120:123], v[72:79], v5
  buffer_load_dwordx4 v6, s[40:43], s51 offen offset:2048 sc1 lds
  v_exp_f32 v96, v96
  v_exp_f32 v97, v97
  v_exp_f32 v98, v98
  v_exp_f32 v99, v99
  v_smfmac_f32_32x32x32_bf16 v[212:227], v[124:127], v[80:87], v5
  ds_read_b128 v[28:31], v232 offset:6144
  ds_read_b64 v[32:33], v233 offset:6144
  v_exp_f32 v100, v100
  s_setprio 1
  v_exp_f32 v101, v101
  v_exp_f32 v102, v102
  v_exp_f32 v103, v103
  s_waitcnt lgkmcnt(0)
  v_mfma_f32_32x32x8_bf16 v[56:71], v[32:33], v[228:229], 0
  s_waitcnt vmcnt(3)
A_f2c:
  s_or_b32 s25, s62, s16
  v_xor_b32 v1, s25, v148
  v_cmp_lt_u32 vcc, 15, v1
  v_cmp_ne_u32 s[26:27], 0, v1
  s_cbranch_vccnz S_f2c
A_f2c_ok:
  s_cmp_eq_u32 s26, 0
  s_cselect_b32 s61, 0, 1
  v_exp_f32 v104, v104
  v_exp_f32 v105, v105
  v_exp_f32 v106, v106
  v_exp_f32 v107, v107
  v_mfma_f32_32x32x16_bf16 v[56:71], v[28:31], v[16:19], v[56:71]
  ds_read_b128 v[120:123], v234 offset:6144
  ds_read_b128 v[124:127], v234 offset:6912
  ds_read_b64_tr_b16 v[164:165], v239 offset:16
  ds_read_b64_tr_b16 v[166:167], v240 offset:16
  v_exp_f32 v108, v108
  v_exp_f32 v109, v109
  v_exp_f32 v110, v110
  v_exp_f32 v111, v111
  v_smfmac_f32_32x32x32_bf16 v[196:211], v[128:131], v[88:95], v5
  v_exp_f32 v112, v112
  v_exp_f32 v113, v113
  v_exp_f32 v114, v114
  v_exp_f32 v115, v115
  v_smfmac_f32_32x32x32_bf16 v[196:211], v[132:135], v[96:103], v5
  ds_read_b64_tr_b16 v[168:169], v239 offset:24
  ds_read_b64_tr_b16 v[170:171], v240 offset:24
  v_exp_f32 v116, v116
  v_exp_f32 v117, v117
  v_exp_f32 v118, v118
  v_exp_f32 v119, v119
  v_mfma_f32_32x32x8_bf16 v[72:87], v[32:33], v[230:231], 0
  v_exp_f32 v56, v56
  v_exp_f32 v57, v57
  v_exp_f32 v58, v58
  v_exp_f32 v59, v59
  v_mfma_f32_32x32x16_bf16 v[72:87], v[28:31], v[20:23], v[72:87]
  s_lshl_b32 s25, s23, 2
  s_add_u32 s25, s25, 163424
  v_mov_b32 v12, s25
  s_add_u32 s26, s60, 1
  v_mov_b32 v13, 163392
  v_mov_b32 v14, s26
  v_exp_f32 v60, v60
  v_exp_f32 v61, v61
  v_exp_f32 v62, v62
  v_exp_f32 v63, v63
  v_smfmac_f32_32x32x32_bf16 v[212:227], v[128:131], v[104:111], v5
  v_exp_f32 v64, v64
  v_exp_f32 v65, v65
  v_exp_f32 v66, v66
  v_exp_f32 v67, v67
  v_smfmac_f32_32x32x32_bf16 v[212:227], v[132:135], v[112:119], v5
  ds_read_b128 v[28:31], v232 offset:9216
  ds_read_b64 v[32:33], v233 offset:9216
  v_exp_f32 v68, v68
  s_setprio 0
  v_exp_f32 v69, v69
  v_exp_f32 v70, v70
  v_exp_f32 v71, v71
  s_waitcnt lgkmcnt(0)
  v_mfma_f32_32x32x8_bf16 v[88:103], v[32:33], v[228:229], 0
  v_exp_f32 v72, v72
  v_exp_f32 v73, v73
  v_exp_f32 v74, v74
  v_exp_f32 v75, v75
  v_mfma_f32_32x32x16_bf16 v[88:103], v[28:31], v[16:19], v[88:103]
  ds_read_b128 v[128:131], v234 offset:9216
  ds_read_b128 v[132:135], v234 offset:9984
  ds_read_b64_tr_b16 v[172:173], v239 offset:32
  ds_read_b64_tr_b16 v[174:175], v240 offset:32
  v_exp_f32 v76, v76
  v_exp_f32 v77, v77
  v_exp_f32 v78, v78
  v_exp_f32 v79, v79
  v_smfmac_f32_32x32x32_bf16 v[196:211], v[120:123], v[56:63], v5
  v_exp_f32 v80, v80
  v_exp_f32 v81, v81
  v_exp_f32 v82, v82
  v_exp_f32 v83, v83
  v_smfmac_f32_32x32x32_bf16 v[196:211], v[124:127], v[64:71], v5
  ds_read_b64_tr_b16 v[176:177], v239 offset:5120
  ds_read_b64_tr_b16 v[178:179], v240 offset:5120
  v_exp_f32 v84, v84
  v_exp_f32 v85, v85
  v_exp_f32 v86, v86
  v_exp_f32 v87, v87
  v_mfma_f32_32x32x8_bf16 v[104:119], v[32:33], v[230:231], 0
  v_exp_f32 v88, v88
  v_exp_f32 v89, v89
  v_exp_f32 v90, v90
  s_waitcnt vmcnt(0) lgkmcnt(0)
  s_barrier
  s_setprio 3
  v_exp_f32 v91, v91
  v_mfma_f32_32x32x16_bf16 v[104:119], v[28:31], v[20:23], v[104:119]
  ds_read_b128 v[28:31], v232 offset:26112
  ds_read_b64 v[32:33], v233 offset:26112
  v_exp_f32 v92, v92
  v_exp_f32 v93, v93
  v_exp_f32 v94, v94
  v_exp_f32 v95, v95
  v_smfmac_f32_32x32x32_bf16 v[212:227], v[120:123], v[72:79], v5
  v_exp_f32 v96, v96
  v_exp_f32 v97, v97
  v_exp_f32 v98, v98
  v_exp_f32 v99, v99
  v_smfmac_f32_32x32x32_bf16 v[212:227], v[124:127], v[80:87], v5
  v_exp_f32 v100, v100
  v_exp_f32 v101, v101
  v_exp_f32 v102, v102
  v_exp_f32 v103, v103
  s_cmp_eq_u32 s24, 0
  s_cbranch_scc1 A_role
  s_waitcnt lgkmcnt(0)
  v_mfma_f32_32x32x8_bf16 v[56:71], v[32:33], v[228:229], 0
  v_exp_f32 v104, v104
  v_exp_f32 v105, v105
  v_exp_f32 v106, v106
  v_exp_f32 v107, v107
  v_mfma_f32_32x32x16_bf16 v[56:71], v[28:31], v[16:19], v[56:71]
  ds_read_b128 v[120:123], v234 offset:26112
  ds_read_b128 v[124:127], v234 offset:26880
  ds_read_b64_tr_b16 v[180:181], v239 offset:5128
  ds_read_b64_tr_b16 v[182:183], v240 offset:5128
  v_exp_f32 v108, v108
  v_exp_f32 v109, v109
  v_exp_f32 v110, v110
  v_exp_f32 v111, v111
  v_smfmac_f32_32x32x32_bf16 v[196:211], v[128:131], v[88:95], v5
  v_exp_f32 v112, v112
  v_exp_f32 v113, v113
  v_exp_f32 v114, v114
  v_exp_f32 v115, v115
  v_smfmac_f32_32x32x32_bf16 v[196:211], v[132:135], v[96:103], v5
  ds_read_b128 v[24:27], v232 offset:29184
  ds_read_b64 v[34:35], v233 offset:29184
  ds_read_b64_tr_b16 v[184:185], v239 offset:5136
  ds_read_b64_tr_b16 v[186:187], v240 offset:5136
  v_exp_f32 v116, v116
  v_exp_f32 v117, v117
  v_exp_f32 v118, v118
  v_exp_f32 v119, v119
  v_mfma_f32_32x32x8_bf16 v[72:87], v[32:33], v[230:231], 0
  v_exp_f32 v56, v56
  v_exp_f32 v57, v57
  v_exp_f32 v58, v58
  v_exp_f32 v59, v59
  v_mfma_f32_32x32x16_bf16 v[72:87], v[28:31], v[20:23], v[72:87]
  v_exp_f32 v60, v60
  v_exp_f32 v61, v61
  v_exp_f32 v62, v62
  v_exp_f32 v63, v63
  v_smfmac_f32_32x32x32_bf16 v[212:227], v[128:131], v[104:111], v5
  v_exp_f32 v64, v64
  v_exp_f32 v65, v65
  v_exp_f32 v66, v66
  v_exp_f32 v67, v67
  v_smfmac_f32_32x32x32_bf16 v[212:227], v[132:135], v[112:119], v5
  ds_read_b128 v[28:31], v232 offset:32256
  ds_read_b64 v[32:33], v233 offset:32256
  v_exp_f32 v68, v68
  v_exp_f32 v69, v69
  v_exp_f32 v70, v70
  v_exp_f32 v71, v71
  s_waitcnt lgkmcnt(4)
  v_mfma_f32_32x32x8_bf16 v[88:103], v[34:35], v[230:231], 0
  v_exp_f32 v72, v72
  v_exp_f32 v73, v73
  v_exp_f32 v74, v74
  v_exp_f32 v75, v75
  v_mfma_f32_32x32x16_bf16 v[88:103], v[24:27], v[20:23], v[88:103]
  ds_read_b128 v[48:51], v234 offset:29184
  ds_read_b128 v[52:55], v234 offset:29952
  ds_read_b64_tr_b16 v[188:189], v239 offset:5144
  ds_read_b64_tr_b16 v[190:191], v240 offset:5144
  v_exp_f32 v76, v76
  v_exp_f32 v77, v77
  v_exp_f32 v78, v78
  v_exp_f32 v79, v79
  v_smfmac_f32_32x32x32_bf16 v[196:211], v[120:123], v[56:63], v5
  v_exp_f32 v80, v80
  v_exp_f32 v81, v81
  v_exp_f32 v82, v82
  v_exp_f32 v83, v83
  v_smfmac_f32_32x32x32_bf16 v[196:211], v[124:127], v[64:71], v5
  ds_read_b128 v[24:27], v232 offset:35328
  ds_read_b64 v[34:35], v233 offset:35328
  ds_read_b64_tr_b16 v[192:193], v239 offset:5152
  ds_read_b64_tr_b16 v[194:195], v240 offset:5152
  v_exp_f32 v84, v84
  v_exp_f32 v85, v85
  v_exp_f32 v86, v86
  v_exp_f32 v87, v87
  s_waitcnt lgkmcnt(8)
  v_mfma_f32_32x32x8_bf16 v[104:119], v[32:33], v[230:231], 0
  v_exp_f32 v88, v88
  v_exp_f32 v89, v89
  v_exp_f32 v90, v90
  v_exp_f32 v91, v91
  v_mfma_f32_32x32x16_bf16 v[104:119], v[28:31], v[20:23], v[104:119]
  ds_read_b128 v[128:131], v234 offset:32256
  ds_read_b128 v[132:135], v234 offset:33024
  v_exp_f32 v92, v92
  v_exp_f32 v93, v93
  ds_write_b128 v241, v[196:199] offset:0
  v_exp_f32 v94, v94
  v_exp_f32 v95, v95
  v_smfmac_f32_32x32x32_bf16 v[212:227], v[120:123], v[72:79], v5
  ds_write_b128 v241, v[200:203] offset:1024
  v_exp_f32 v96, v96
  v_exp_f32 v97, v97
  v_exp_f32 v98, v98
  v_exp_f32 v99, v99
  v_smfmac_f32_32x32x32_bf16 v[212:227], v[124:127], v[80:87], v5
  ds_write_b128 v241, v[204:207] offset:2048
  s_mov_b64 exec, 1
  ds_write_b32 v12, v14 offset:16
  s_mov_b64 exec, -1
  ds_read_b128 v[28:31], v232 offset:16896
  ds_read_b64 v[32:33], v233 offset:16896
  v_exp_f32 v100, v100
  v_exp_f32 v101, v101
  v_exp_f32 v102, v102
  v_exp_f32 v103, v103
  s_setprio 1
  s_waitcnt lgkmcnt(10)
  v_mfma_f32_32x32x8_bf16 v[56:71], v[34:35], v[230:231], 0
  v_exp_f32 v104, v104
  v_exp_f32 v105, v105
  v_exp_f32 v106, v106
  v_exp_f32 v107, v107
  v_mfma_f32_32x32x16_bf16 v[56:71], v[24:27], v[20:23], v[56:71]
  ds_read_b128 v[120:123], v234 offset:35328
  ds_read_b128 v[124:127], v234 offset:36096
  v_exp_f32 v108, v108
  v_exp_f32 v109, v109
  v_exp_f32 v110, v110
  v_exp_f32 v111, v111
  v_smfmac_f32_32x32x32_bf16 v[212:227], v[48:51], v[88:95], v5
  v_exp_f32 v112, v112
  v_exp_f32 v113, v113
  v_exp_f32 v114, v114
  v_exp_f32 v115, v115
  v_smfmac_f32_32x32x32_bf16 v[212:227], v[52:55], v[96:103], v5
  ds_read_b128 v[24:27], v232 offset:19968
  ds_read_b64 v[34:35], v233 offset:19968
  v_exp_f32 v116, v116
  v_exp_f32 v117, v117
  v_exp_f32 v118, v118
  v_exp_f32 v119, v119
  s_waitcnt lgkmcnt(4)
  v_mfma_f32_32x32x8_bf16 v[72:87], v[32:33], v[230:231], 0
  v_exp_f32 v56, v56
  v_exp_f32 v57, v57
  v_exp_f32 v58, v58
  v_exp_f32 v59, v59
  v_mfma_f32_32x32x16_bf16 v[72:87], v[28:31], v[20:23], v[72:87]
  ds_read_b128 v[48:51], v234 offset:16896
  ds_read_b128 v[52:55], v234 offset:17664
  v_exp_f32 v60, v60
  v_exp_f32 v61, v61
  v_exp_f32 v62, v62
  v_exp_f32 v63, v63
  v_smfmac_f32_32x32x32_bf16 v[212:227], v[128:131], v[104:111], v5
  v_exp_f32 v64, v64
  v_exp_f32 v65, v65
  v_exp_f32 v66, v66
  v_exp_f32 v67, v67
  v_smfmac_f32_32x32x32_bf16 v[212:227], v[132:135], v[112:119], v5
  ds_read_b128 v[28:31], v232 offset:23040
  ds_read_b64 v[32:33], v233 offset:23040
  v_exp_f32 v68, v68
  v_exp_f32 v69, v69
  v_exp_f32 v70, v70
  v_exp_f32 v71, v71
  s_waitcnt lgkmcnt(4)
  v_mfma_f32_32x32x8_bf16 v[88:103], v[34:35], v[230:231], 0
  v_exp_f32 v72, v72
  v_exp_f32 v73, v73
  v_exp_f32 v74, v74
  v_exp_f32 v75, v75
  v_mfma_f32_32x32x16_bf16 v[88:103], v[24:27], v[20:23], v[88:103]
  ds_read_b128 v[128:131], v234 offset:19968
  ds_read_b128 v[132:135], v234 offset:20736
  v_exp_f32 v76, v76
  v_exp_f32 v77, v77
  v_exp_f32 v78, v78
  v_exp_f32 v79, v79
  v_smfmac_f32_32x32x32_bf16 v[212:227], v[120:123], v[56:63], v5
  ds_read_b32 v8, v12 offset:0
  ds_read_b128 v[36:39], v242 offset:0
  ds_read_b128 v[40:43], v242 offset:1024
  ds_read_b128 v[44:47], v242 offset:2048
  v_exp_f32 v80, v80
  v_exp_f32 v81, v81
  v_exp_f32 v82, v82
  v_exp_f32 v83, v83
  v_smfmac_f32_32x32x32_bf16 v[212:227], v[124:127], v[64:71], v5
  v_exp_f32 v84, v84
  v_exp_f32 v85, v85
  v_exp_f32 v86, v86
  v_exp_f32 v87, v87
  s_waitcnt lgkmcnt(6)
  v_mfma_f32_32x32x8_bf16 v[104:119], v[32:33], v[230:231], 0
  v_exp_f32 v88, v88
  v_exp_f32 v89, v89
  v_exp_f32 v90, v90
  v_exp_f32 v91, v91
  v_mfma_f32_32x32x16_bf16 v[104:119], v[28:31], v[20:23], v[104:119]
  ds_read_b128 v[120:123], v234 offset:23040
  ds_read_b128 v[124:127], v234 offset:23808
  v_exp_f32 v92, v92
  s_waitcnt lgkmcnt(2)
  v_cmp_ge_u32 vcc, s60, v8
  s_nop 0
  s_cbranch_vccnz S_x1
A_x1:
  v_add_f32 v212, v212, v36
  v_add_f32 v213, v213, v37
  v_add_f32 v214, v214, v38
  v_add_f32 v215, v215, v39
  v_add_f32 v216, v216, v40
  v_add_f32 v217, v217, v41
  v_add_f32 v218, v218, v42
  v_add_f32 v219, v219, v43
  v_add_f32 v220, v220, v44
  v_add_f32 v221, v221, v45
  v_add_f32 v222, v222, v46
  v_add_f32 v223, v223, v47
  v_exp_f32 v93, v93
  v_exp_f32 v94, v94
  v_exp_f32 v95, v95
  v_smfmac_f32_32x32x32_bf16 v[212:227], v[48:51], v[72:79], v5
  v_exp_f32 v96, v96
  v_exp_f32 v97, v97
  v_exp_f32 v98, v98
  v_exp_f32 v99, v99
  v_smfmac_f32_32x32x32_bf16 v[212:227], v[52:55], v[80:87], v5
  v_exp_f32 v100, v100
  v_exp_f32 v101, v101
  v_exp_f32 v102, v102
  v_exp_f32 v103, v103
  v_exp_f32 v104, v104
  v_exp_f32 v105, v105
  v_smfmac_f32_32x32x32_bf16 v[212:227], v[128:131], v[88:95], v5
  v_exp_f32 v106, v106
  v_exp_f32 v107, v107
  v_exp_f32 v108, v108
  v_exp_f32 v109, v109
  v_smfmac_f32_32x32x32_bf16 v[212:227], v[132:135], v[96:103], v5
  v_exp_f32 v110, v110
  v_exp_f32 v111, v111
  v_exp_f32 v112, v112
  v_exp_f32 v113, v113
  s_waitcnt lgkmcnt(0)
  v_smfmac_f32_32x32x32_bf16 v[212:227], v[120:123], v[104:111], v5
  v_exp_f32 v114, v114
  v_exp_f32 v115, v115
  v_exp_f32 v116, v116
  v_exp_f32 v117, v117
  v_exp_f32 v118, v118
  v_exp_f32 v119, v119
  s_mov_b32 s49, 0
  s_nop 0
  v_smfmac_f32_32x32x32_bf16 v[212:227], v[124:127], v[112:119], v5
  ds_read_b64_tr_b16 v[56:57], v239 offset:10240
  ds_read_b64_tr_b16 v[58:59], v240 offset:10240
  ds_read_b64_tr_b16 v[60:61], v239 offset:10248
  ds_read_b64_tr_b16 v[62:63], v240 offset:10248
  ds_read_b64_tr_b16 v[64:65], v239 offset:10256
  ds_read_b64_tr_b16 v[66:67], v240 offset:10256
  ds_read_b64_tr_b16 v[68:69], v239 offset:10264
  ds_read_b64_tr_b16 v[70:71], v240 offset:10264
  ds_read_b64_tr_b16 v[72:73], v239 offset:10272
  ds_read_b64_tr_b16 v[74:75], v240 offset:10272
  s_nop 1
  v_mov_b32 v10, v220
  v_mov_b32 v11, v220
  s_nop 1
  v_permlane32_swap_b32 v10, v11
  s_nop 1
  v_rcp_f32 v10, v11
  v_subrev_u32 v11, 0x30800000, v11
  v_cmp_lt_u32 vcc, 503316480, v11
  v_mul_f32 v212, v212, v10
  v_mul_f32 v213, v213, v10
  v_mul_f32 v214, v214, v10
  v_mul_f32 v215, v215, v10
  v_mul_f32 v216, v216, v10
  v_mul_f32 v217, v217, v10
  v_mul_f32 v218, v218, v10
  v_mul_f32 v219, v219, v10
  v_mul_f32 v220, v220, v10
  v_mul_f32 v221, v221, v10
  v_mul_f32 v222, v222, v10
  v_mul_f32 v223, v223, v10
  s_or_b64 s[26:27], vcc, s[60:61]
  v_cvt_pk_bf16_f32 v48, v212, v213
  v_cvt_pk_bf16_f32 v49, v214, v215
  v_cvt_pk_bf16_f32 v50, v216, v217
  v_cvt_pk_bf16_f32 v51, v218, v219
  v_cvt_pk_bf16_f32 v52, v220, v221
  v_cvt_pk_bf16_f32 v53, v222, v223
  s_cbranch_scc1 O_slow1
  buffer_store_dwordx4 v[48:51], v6, s[40:43], s28 offen
  s_mov_b32 exec_hi, 0
  buffer_store_dwordx2 v[52:53], v147, s[40:43], s29 offen
O_std1:
  s_mov_b64 exec, 1
  ds_add_u32 v13, v14
  s_mov_b64 exec, -1
  ds_read_b64_tr_b16 v[76:77], v239 offset:15360
  ds_read_b64_tr_b16 v[78:79], v240 offset:15360
  ds_read_b64_tr_b16 v[80:81], v239 offset:15368
  ds_read_b64_tr_b16 v[82:83], v240 offset:15368
  ds_read_b64_tr_b16 v[84:85], v239 offset:15376
  ds_read_b64_tr_b16 v[86:87], v240 offset:15376
  ds_read_b64_tr_b16 v[88:89], v239 offset:15384
  ds_read_b64_tr_b16 v[90:91], v240 offset:15384
  ds_read_b64_tr_b16 v[92:93], v239 offset:15392
  ds_read_b64_tr_b16 v[94:95], v240 offset:15392
  ds_read_b64_tr_b16 v[96:97], v239 offset:20480
  ds_read_b64_tr_b16 v[98:99], v240 offset:20480
  ds_read_b64_tr_b16 v[100:101], v239 offset:20488
  ds_read_b64_tr_b16 v[102:103], v240 offset:20488
  ds_read_b64_tr_b16 v[104:105], v239 offset:20496
  ds_read_b64_tr_b16 v[106:107], v240 offset:20496
  ds_read_b64_tr_b16 v[108:109], v239 offset:20504
  ds_read_b64_tr_b16 v[110:111], v240 offset:20504
  ds_read_b64_tr_b16 v[112:113], v239 offset:20512
  ds_read_b64_tr_b16 v[114:115], v240 offset:20512
  ds_read_b64_tr_b16 v[116:117], v239 offset:25600
  ds_read_b64_tr_b16 v[118:119], v240 offset:25600
  ds_read_b64_tr_b16 v[120:121], v239 offset:25608
  ds_read_b64_tr_b16 v[122:123], v240 offset:25608
  ds_read_b64_tr_b16 v[124:125], v239 offset:25616
  ds_read_b64_tr_b16 v[126:127], v240 offset:25616
  s_waitcnt vmcnt(0)
  buffer_load_dwordx4 v[16:19], v236, s[40:43], s4 offen offset:0 sc1
  buffer_load_dwordx4 v[20:23], v236, s[40:43], s4 offen offset:2048 sc1
  buffer_load_dwordx4 v[24:27], v236, s[40:43], s5 offen offset:0 sc1
  buffer_load_dwordx4 v[28:31], v236, s[40:43], s5 offen offset:2048 sc1
  buffer_load_dwordx2 v[32:33], v237, s[40:43], s4 offen sc1
  buffer_load_dwordx2 v[34:35], v237, s[40:43], s4 offen offset:256 sc1
  buffer_load_dwordx4 v[36:39], v236, s[40:43], s6 offen offset:0 sc1
  buffer_load_dwordx4 v[40:43], v236, s[40:43], s6 offen offset:2048 sc1
  buffer_load_dwordx4 v[44:47], v236, s[40:43], s7 offen offset:0 sc1
  buffer_load_dwordx4 v[48:51], v236, s[40:43], s7 offen offset:2048 sc1
  buffer_load_dwordx2 v[52:53], v237, s[40:43], s6 offen sc1
  buffer_load_dwordx2 v[54:55], v237, s[40:43], s6 offen offset:256 sc1
  ds_read_b64_tr_b16 v[128:129], v239 offset:25624
  ds_read_b64_tr_b16 v[130:131], v240 offset:25624
  ds_read_b64_tr_b16 v[132:133], v239 offset:25632
  ds_read_b64_tr_b16 v[134:135], v240 offset:25632
  ds_read_b64_tr_b16 v[136:137], v239 offset:30720
  ds_read_b64_tr_b16 v[138:139], v240 offset:30720
  ds_read_b64_tr_b16 v[140:141], v239 offset:30728
  ds_read_b64_tr_b16 v[142:143], v240 offset:30728
  ds_read_b64_tr_b16 v[144:145], v239 offset:30736
  ds_read_b64_tr_b16 v[146:147], v240 offset:30736
  ds_read_b64_tr_b16 v[148:149], v239 offset:30744
  ds_read_b64_tr_b16 v[150:151], v240 offset:30744
  ds_read_b64_tr_b16 v[152:153], v239 offset:30752
  ds_read_b64_tr_b16 v[154:155], v240 offset:30752
  ds_read_b64_tr_b16 v[196:197], v239 offset:35840
  ds_read_b64_tr_b16 v[198:199], v240 offset:35840
  ds_read_b64_tr_b16 v[200:201], v239 offset:35848
  ds_read_b64_tr_b16 v[202:203], v240 offset:35848
  ds_read_b64_tr_b16 v[204:205], v239 offset:35856
  ds_read_b64_tr_b16 v[206:207], v240 offset:35856
  ds_read_b64_tr_b16 v[208:209], v239 offset:35864
  ds_read_b64_tr_b16 v[210:211], v240 offset:35864
  ds_read_b64_tr_b16 v[212:213], v239 offset:35872
  ds_read_b64_tr_b16 v[214:215], v240 offset:35872
  s_setprio 0
  s_waitcnt vmcnt(11)
  v_max3_u32 v7, v16, v17, v18
  v_max_u32 v7, v7, v19
  v_cmp_eq_u32 vcc, -1, v7
  s_nop 0
  s_cbranch_vccnz O_c01_r
O_c01_ok:
  v_mfma_f32_16x16x32_bf16 v[216:219], v[156:159], v[16:19], 0
  s_waitcnt vmcnt(10)
  v_max3_u32 v7, v20, v21, v22
  v_mfma_f32_16x16x32_bf16 v[220:223], v[160:163], v[16:19], 0
  v_max_u32 v7, v7, v23
  v_mfma_f32_16x16x32_bf16 v[224:227], v[164:167], v[16:19], 0
  v_cmp_eq_u32 vcc, -1, v7
  v_mfma_f32_16x16x32_bf16 v[228:231], v[168:171], v[16:19], 0
  v_mfma_f32_16x16x32_bf16 v[232:235], v[172:175], v[16:19], 0
  s_cbranch_vccnz O_c11_r
O_c11_ok:
  v_mfma_f32_16x16x32_bf16 v[216:219], v[176:179], v[20:23], v[216:219]
  s_waitcnt vmcnt(9)
  v_max3_u32 v7, v24, v25, v26
  v_mfma_f32_16x16x32_bf16 v[220:223], v[180:183], v[20:23], v[220:223]
  v_max_u32 v7, v7, v27
  v_mfma_f32_16x16x32_bf16 v[224:227], v[184:187], v[20:23], v[224:227]
  v_cmp_eq_u32 vcc, -1, v7
  v_mfma_f32_16x16x32_bf16 v[228:231], v[188:191], v[20:23], v[228:231]
  v_mfma_f32_16x16x32_bf16 v[232:235], v[192:195], v[20:23], v[232:235]
  s_cbranch_vccnz O_c21_r
O_c21_ok:
  s_waitcnt lgkmcnt(14)
  v_mfma_f32_16x16x32_bf16 v[216:219], v[56:59], v[24:27], v[216:219]
  s_waitcnt vmcnt(8)
  v_max3_u32 v7, v28, v29, v30
  v_mfma_f32_16x16x32_bf16 v[220:223], v[60:63], v[24:27], v[220:223]
  v_max_u32 v7, v7, v31
  v_mfma_f32_16x16x32_bf16 v[224:227], v[64:67], v[24:27], v[224:227]
  v_cmp_eq_u32 vcc, -1, v7
  v_mfma_f32_16x16x32_bf16 v[228:231], v[68:71], v[24:27], v[228:231]
  v_mfma_f32_16x16x32_bf16 v[232:235], v[72:75], v[24:27], v[232:235]
  s_cbranch_vccnz O_c31_r
O_c31_ok:
  v_mfma_f32_16x16x32_bf16 v[216:219], v[76:79], v[28:31], v[216:219]
  ds_read_b64_tr_b16 v[156:157], v239 offset:40960
  s_waitcnt vmcnt(6)
  v_max3_u32 v7, v32, v33, v34
  v_mfma_f32_16x16x32_bf16 v[220:223], v[80:83], v[28:31], v[220:223]
  ds_read_b64_tr_b16 v[158:159], v240 offset:40960
  v_max_u32 v7, v7, v35
  v_mfma_f32_16x16x32_bf16 v[224:227], v[84:87], v[28:31], v[224:227]
  ds_read_b64_tr_b16 v[160:161], v239 offset:40968
  v_cmp_eq_u32 vcc, -1, v7
  v_mfma_f32_16x16x32_bf16 v[228:231], v[88:91], v[28:31], v[228:231]
  ds_read_b64_tr_b16 v[162:163], v240 offset:40968
  v_mfma_f32_16x16x32_bf16 v[232:235], v[92:95], v[28:31], v[232:235]
  ds_read_b64_tr_b16 v[164:165], v239 offset:40976
  s_cbranch_vccnz O_c41_r
O_c41_ok:
  v_mfma_f32_16x16x32_bf16 v[216:219], v[96:99], v[32:35], v[216:219]
  ds_read_b64_tr_b16 v[166:167], v240 offset:40976
  s_waitcnt vmcnt(5)
  v_max3_u32 v7, v36, v37, v38
  v_mfma_f32_16x16x32_bf16 v[220:223], v[100:103], v[32:35], v[220:223]
  ds_read_b64_tr_b16 v[168:169], v239 offset:40984
  v_max_u32 v7, v7, v39
  v_mfma_f32_16x16x32_bf16 v[224:227], v[104:107], v[32:35], v[224:227]
  ds_read_b64_tr_b16 v[170:171], v240 offset:40984
  v_cmp_eq_u32 vcc, -1, v7
  v_mfma_f32_16x16x32_bf16 v[228:231], v[108:111], v[32:35], v[228:231]
  ds_read_b64_tr_b16 v[172:173], v239 offset:40992
  v_mfma_f32_16x16x32_bf16 v[232:235], v[112:115], v[32:35], v[232:235]
  ds_read_b64_tr_b16 v[174:175], v240 offset:40992
  s_cbranch_vccnz O_c51_r
O_c51_ok:
  v_mfma_f32_16x16x32_bf16 v[216:219], v[116:119], v[36:39], v[216:219]
  ds_read_b64_tr_b16 v[176:177], v239 offset:46080
  s_waitcnt vmcnt(4)
  v_max3_u32 v7, v40, v41, v42
  v_mfma_f32_16x16x32_bf16 v[220:223], v[120:123], v[36:39], v[220:223]
  ds_read_b64_tr_b16 v[178:179], v240 offset:46080
  v_max_u32 v7, v7, v43
  v_mfma_f32_16x16x32_bf16 v[224:227], v[124:127], v[36:39], v[224:227]
  ds_read_b64_tr_b16 v[180:181], v239 offset:46088
  v_cmp_eq_u32 vcc, -1, v7
  v_mfma_f32_16x16x32_bf16 v[228:231], v[128:131], v[36:39], v[228:231]
  ds_read_b64_tr_b16 v[182:183], v240 offset:46088
  v_mfma_f32_16x16x32_bf16 v[232:235], v[132:135], v[36:39], v[232:235]
  ds_read_b64_tr_b16 v[184:185], v239 offset:46096
  s_cbranch_vccnz O_c61_r
O_c61_ok:
  s_waitcnt lgkmcnt(14)
  v_mfma_f32_16x16x32_bf16 v[216:219], v[136:139], v[40:43], v[216:219]
  ds_read_b64_tr_b16 v[186:187], v240 offset:46096
  s_waitcnt vmcnt(3)
  v_max3_u32 v7, v44, v45, v46
  v_mfma_f32_16x16x32_bf16 v[220:223], v[140:143], v[40:43], v[220:223]
  ds_read_b64_tr_b16 v[188:189], v239 offset:46104
  v_max_u32 v7, v7, v47
  v_mfma_f32_16x16x32_bf16 v[224:227], v[144:147], v[40:43], v[224:227]
  ds_read_b64_tr_b16 v[190:191], v240 offset:46104
  v_cmp_eq_u32 vcc, -1, v7
  v_mfma_f32_16x16x32_bf16 v[228:231], v[148:151], v[40:43], v[228:231]
  ds_read_b64_tr_b16 v[192:193], v239 offset:46112
  v_mfma_f32_16x16x32_bf16 v[232:235], v[152:155], v[40:43], v[232:235]
  ds_read_b64_tr_b16 v[194:195], v240 offset:46112
  s_cbranch_vccnz O_c71_r
O_c71_ok:
  v_mfma_f32_16x16x32_bf16 v[216:219], v[196:199], v[44:47], v[216:219]
  s_waitcnt vmcnt(2)
  v_max3_u32 v7, v48, v49, v50
  v_mfma_f32_16x16x32_bf16 v[220:223], v[200:203], v[44:47], v[220:223]
  v_max_u32 v7, v7, v51
  v_mfma_f32_16x16x32_bf16 v[224:227], v[204:207], v[44:47], v[224:227]
  v_cmp_eq_u32 vcc, -1, v7
  v_mfma_f32_16x16x32_bf16 v[228:231], v[208:211], v[44:47], v[228:231]
  v_mfma_f32_16x16x32_bf16 v[232:235], v[212:215], v[44:47], v[232:235]
  s_cbranch_vccnz O_c81_r
O_c81_ok:
  s_waitcnt lgkmcnt(10)
  v_mfma_f32_16x16x32_bf16 v[216:219], v[156:159], v[48:51], v[216:219]
  ds_read_b32 v8, v12
  s_waitcnt vmcnt(0)
  v_max3_u32 v7, v52, v53, v54
  v_mfma_f32_16x16x32_bf16 v[220:223], v[160:163], v[48:51], v[220:223]
  ds_read_b128 v[56:59], v238 offset:0
  v_max_u32 v7, v7, v55
  v_mfma_f32_16x16x32_bf16 v[224:227], v[164:167], v[48:51], v[224:227]
  ds_read_b128 v[60:63], v238 offset:1024
  v_cmp_eq_u32 vcc, -1, v7
  v_mfma_f32_16x16x32_bf16 v[228:231], v[168:171], v[48:51], v[228:231]
  ds_read_b128 v[64:67], v238 offset:2048
  v_mfma_f32_16x16x32_bf16 v[232:235], v[172:175], v[48:51], v[232:235]
  ds_read_b128 v[68:71], v238 offset:3072
  s_cbranch_vccnz O_c91_r
O_c91_ok:
  s_waitcnt lgkmcnt(5)
  v_mfma_f32_16x16x32_bf16 v[216:219], v[176:179], v[52:55], v[216:219]
  ds_read_b128 v[72:75], v238 offset:4096
  v_mfma_f32_16x16x32_bf16 v[220:223], v[180:183], v[52:55], v[220:223]
  v_mfma_f32_16x16x32_bf16 v[224:227], v[184:187], v[52:55], v[224:227]
  v_mfma_f32_16x16x32_bf16 v[228:231], v[188:191], v[52:55], v[228:231]
  v_mfma_f32_16x16x32_bf16 v[232:235], v[192:195], v[52:55], v[232:235]
O_pc:
  s_waitcnt lgkmcnt(0)
  v_cmp_ne_u32 vcc, v5, v8
  s_nop 0
  s_cbranch_vccnz O_pr
O_pok:
  v_pk_add_f32 v[216:217], v[216:217], v[56:57]
  v_pk_add_f32 v[218:219], v[218:219], v[58:59]
  v_cvt_pk_bf16_f32 v56, v216, v217
  v_cvt_pk_bf16_f32 v57, v218, v219
  ds_write_b64 v243, v[56:57] offset:0
  v_pk_add_f32 v[220:221], v[220:221], v[60:61]
  v_pk_add_f32 v[222:223], v[222:223], v[62:63]
  v_cvt_pk_bf16_f32 v58, v220, v221
  v_cvt_pk_bf16_f32 v59, v222, v223
  ds_write_b64 v243, v[58:59] offset:8
  v_pk_add_f32 v[224:225], v[224:225], v[64:65]
  v_pk_add_f32 v[226:227], v[226:227], v[66:67]
  v_cvt_pk_bf16_f32 v60, v224, v225
  v_cvt_pk_bf16_f32 v61, v226, v227
  ds_write_b64 v243, v[60:61] offset:16
  v_pk_add_f32 v[228:229], v[228:229], v[68:69]
  v_pk_add_f32 v[230:231], v[230:231], v[70:71]
  v_cvt_pk_bf16_f32 v62, v228, v229
  v_cvt_pk_bf16_f32 v63, v230, v231
  ds_write_b64 v243, v[62:63] offset:24
  v_pk_add_f32 v[232:233], v[232:233], v[72:73]
  v_pk_add_f32 v[234:235], v[234:235], v[74:75]
  v_cvt_pk_bf16_f32 v64, v232, v233
  v_cvt_pk_bf16_f32 v65, v234, v235
  ds_write_b64 v243, v[64:65] offset:32
  ds_read_b128 v[16:19], v244
  ds_read_b128 v[20:23], v245
  ds_read_b128 v[24:27], v246
  s_waitcnt lgkmcnt(2)
  buffer_store_dwordx4 v[16:19], v247, s[44:47], 0 offen
  s_waitcnt lgkmcnt(1)
  buffer_store_dwordx4 v[20:23], v248, s[44:47], 0 offen
  s_waitcnt lgkmcnt(0)
  s_mov_b32 exec_hi, 0
  buffer_store_dwordx4 v[24:27], v249, s[44:47], 0 offen
  s_endpgm
.p2align 5
  s_nop 0
A_role:
  s_waitcnt lgkmcnt(0)
  v_mfma_f32_32x32x8_bf16 v[56:71], v[32:33], v[228:229], 0
  v_exp_f32 v104, v104
  v_exp_f32 v105, v105
  v_exp_f32 v106, v106
  v_exp_f32 v107, v107
  v_mfma_f32_32x32x16_bf16 v[56:71], v[28:31], v[16:19], v[56:71]
  ds_read_b128 v[120:123], v234 offset:26112
  ds_read_b128 v[124:127], v234 offset:26880
  ds_read_b64_tr_b16 v[180:181], v239 offset:5128
  ds_read_b64_tr_b16 v[182:183], v240 offset:5128
  v_exp_f32 v108, v108
  v_exp_f32 v109, v109
  v_exp_f32 v110, v110
  v_exp_f32 v111, v111
  v_smfmac_f32_32x32x32_bf16 v[196:211], v[128:131], v[88:95], v5
  v_exp_f32 v112, v112
  v_exp_f32 v113, v113
  v_exp_f32 v114, v114
  v_exp_f32 v115, v115
  v_smfmac_f32_32x32x32_bf16 v[196:211], v[132:135], v[96:103], v5
  ds_read_b128 v[24:27], v232 offset:29184
  ds_read_b64 v[34:35], v233 offset:29184
  ds_read_b64_tr_b16 v[184:185], v239 offset:5136
  ds_read_b64_tr_b16 v[186:187], v240 offset:5136
  v_exp_f32 v116, v116
  v_exp_f32 v117, v117
  v_exp_f32 v118, v118
  v_exp_f32 v119, v119
  v_mfma_f32_32x32x8_bf16 v[72:87], v[32:33], v[230:231], 0
  v_exp_f32 v56, v56
  v_exp_f32 v57, v57
  v_exp_f32 v58, v58
  v_exp_f32 v59, v59
  v_mfma_f32_32x32x16_bf16 v[72:87], v[28:31], v[20:23], v[72:87]
  v_exp_f32 v60, v60
  v_exp_f32 v61, v61
  v_exp_f32 v62, v62
  v_exp_f32 v63, v63
  v_smfmac_f32_32x32x32_bf16 v[212:227], v[128:131], v[104:111], v5
  v_exp_f32 v64, v64
  v_exp_f32 v65, v65
  v_exp_f32 v66, v66
  v_exp_f32 v67, v67
  v_smfmac_f32_32x32x32_bf16 v[212:227], v[132:135], v[112:119], v5
  ds_read_b128 v[28:31], v232 offset:32256
  ds_read_b64 v[32:33], v233 offset:32256
  v_exp_f32 v68, v68
  v_exp_f32 v69, v69
  v_exp_f32 v70, v70
  v_exp_f32 v71, v71
  s_waitcnt lgkmcnt(4)
  v_mfma_f32_32x32x8_bf16 v[88:103], v[34:35], v[230:231], 0
  v_exp_f32 v72, v72
  v_exp_f32 v73, v73
  v_exp_f32 v74, v74
  v_exp_f32 v75, v75
  v_mfma_f32_32x32x16_bf16 v[88:103], v[24:27], v[20:23], v[88:103]
  ds_read_b128 v[48:51], v234 offset:29184
  ds_read_b128 v[52:55], v234 offset:29952
  ds_read_b64_tr_b16 v[188:189], v239 offset:5144
  ds_read_b64_tr_b16 v[190:191], v240 offset:5144
  v_exp_f32 v76, v76
  v_exp_f32 v77, v77
  v_exp_f32 v78, v78
  v_exp_f32 v79, v79
  v_smfmac_f32_32x32x32_bf16 v[196:211], v[120:123], v[56:63], v5
  v_exp_f32 v80, v80
  v_exp_f32 v81, v81
  v_exp_f32 v82, v82
  v_exp_f32 v83, v83
  v_smfmac_f32_32x32x32_bf16 v[196:211], v[124:127], v[64:71], v5
  ds_read_b128 v[24:27], v232 offset:35328
  ds_read_b64 v[34:35], v233 offset:35328
  ds_read_b64_tr_b16 v[192:193], v239 offset:5152
  ds_read_b64_tr_b16 v[194:195], v240 offset:5152
  v_exp_f32 v84, v84
  v_exp_f32 v85, v85
  v_exp_f32 v86, v86
  v_exp_f32 v87, v87
  s_waitcnt lgkmcnt(8)
  v_mfma_f32_32x32x8_bf16 v[104:119], v[32:33], v[230:231], 0
  v_exp_f32 v88, v88
  v_exp_f32 v89, v89
  v_exp_f32 v90, v90
  v_exp_f32 v91, v91
  v_mfma_f32_32x32x16_bf16 v[104:119], v[28:31], v[20:23], v[104:119]
  ds_read_b128 v[128:131], v234 offset:32256
  ds_read_b128 v[132:135], v234 offset:33024
  v_exp_f32 v92, v92
  v_exp_f32 v93, v93
  ds_write_b128 v241, v[196:199] offset:0
  v_exp_f32 v94, v94
  v_exp_f32 v95, v95
  v_smfmac_f32_32x32x32_bf16 v[212:227], v[120:123], v[72:79], v5
  ds_write_b128 v241, v[200:203] offset:1024
  v_exp_f32 v96, v96
  v_exp_f32 v97, v97
  v_exp_f32 v98, v98
  v_exp_f32 v99, v99
  v_smfmac_f32_32x32x32_bf16 v[212:227], v[124:127], v[80:87], v5
  ds_write_b128 v241, v[204:207] offset:2048
  s_mov_b64 exec, 1
  ds_write_b32 v12, v14 offset:0
  s_mov_b64 exec, -1
  ds_read_b128 v[28:31], v232 offset:41472
  ds_read_b64 v[32:33], v233 offset:41472
  v_exp_f32 v100, v100
  v_exp_f32 v101, v101
  v_exp_f32 v102, v102
  v_exp_f32 v103, v103
  s_setprio 1
  s_waitcnt lgkmcnt(10)
  v_mfma_f32_32x32x8_bf16 v[56:71], v[34:35], v[230:231], 0
  v_exp_f32 v104, v104
  v_exp_f32 v105, v105
  v_exp_f32 v106, v106
  v_exp_f32 v107, v107
  v_mfma_f32_32x32x16_bf16 v[56:71], v[24:27], v[20:23], v[56:71]
  ds_read_b128 v[120:123], v234 offset:35328
  ds_read_b128 v[124:127], v234 offset:36096
  v_exp_f32 v108, v108
  v_exp_f32 v109, v109
  v_exp_f32 v110, v110
  v_exp_f32 v111, v111
  v_smfmac_f32_32x32x32_bf16 v[212:227], v[48:51], v[88:95], v5
  v_exp_f32 v112, v112
  v_exp_f32 v113, v113
  v_exp_f32 v114, v114
  v_exp_f32 v115, v115
  v_smfmac_f32_32x32x32_bf16 v[212:227], v[52:55], v[96:103], v5
  ds_read_b128 v[24:27], v232 offset:44544
  ds_read_b64 v[34:35], v233 offset:44544
  v_exp_f32 v116, v116
  v_exp_f32 v117, v117
  v_exp_f32 v118, v118
  v_exp_f32 v119, v119
  s_setprio 2
  s_waitcnt lgkmcnt(4)
  v_mfma_f32_32x32x8_bf16 v[72:87], v[32:33], v[230:231], 0
  v_exp_f32 v56, v56
  v_exp_f32 v57, v57
  v_exp_f32 v58, v58
  v_exp_f32 v59, v59
  v_mfma_f32_32x32x16_bf16 v[72:87], v[28:31], v[20:23], v[72:87]
  ds_read_b128 v[48:51], v234 offset:41472
  ds_read_b128 v[52:55], v234 offset:42240
  v_exp_f32 v60, v60
  v_exp_f32 v61, v61
  v_exp_f32 v62, v62
  v_exp_f32 v63, v63
  v_smfmac_f32_32x32x32_bf16 v[212:227], v[128:131], v[104:111], v5
  ds_read_b32 v8, v12 offset:16
  ds_read_b128 v[36:39], v242 offset:0
  ds_read_b128 v[40:43], v242 offset:1024
  ds_read_b128 v[44:47], v242 offset:2048
  v_exp_f32 v64, v64
  v_exp_f32 v65, v65
  v_exp_f32 v66, v66
  v_exp_f32 v67, v67
  v_smfmac_f32_32x32x32_bf16 v[212:227], v[132:135], v[112:119], v5
  ds_read_b128 v[28:31], v232 offset:47616
  ds_read_b64 v[32:33], v233 offset:47616
  v_exp_f32 v68, v68
  v_exp_f32 v69, v69
  v_exp_f32 v70, v70
  v_exp_f32 v71, v71
  s_waitcnt lgkmcnt(8)
  v_mfma_f32_32x32x8_bf16 v[88:103], v[34:35], v[230:231], 0
  v_exp_f32 v72, v72
  v_exp_f32 v73, v73
  v_exp_f32 v74, v74
  v_exp_f32 v75, v75
  v_mfma_f32_32x32x16_bf16 v[88:103], v[24:27], v[20:23], v[88:103]
  ds_read_b128 v[128:131], v234 offset:44544
  ds_read_b128 v[132:135], v234 offset:45312
  v_exp_f32 v76, v76
  s_waitcnt lgkmcnt(4)
  v_cmp_ge_u32 vcc, s60, v8
  s_nop 0
  s_cbranch_vccnz S_x0
A_x0:
  v_add_f32 v212, v212, v36
  v_add_f32 v213, v213, v37
  v_add_f32 v214, v214, v38
  v_add_f32 v215, v215, v39
  v_add_f32 v216, v216, v40
  v_add_f32 v217, v217, v41
  v_add_f32 v218, v218, v42
  v_add_f32 v219, v219, v43
  v_add_f32 v220, v220, v44
  v_add_f32 v221, v221, v45
  v_add_f32 v222, v222, v46
  v_add_f32 v223, v223, v47
  v_exp_f32 v77, v77
  v_exp_f32 v78, v78
  v_exp_f32 v79, v79
  v_smfmac_f32_32x32x32_bf16 v[212:227], v[120:123], v[56:63], v5
  v_exp_f32 v80, v80
  v_exp_f32 v81, v81
  v_exp_f32 v82, v82
  v_exp_f32 v83, v83
  v_smfmac_f32_32x32x32_bf16 v[212:227], v[124:127], v[64:71], v5
  v_exp_f32 v84, v84
  v_exp_f32 v85, v85
  v_exp_f32 v86, v86
  v_exp_f32 v87, v87
  s_waitcnt lgkmcnt(2)
  v_mfma_f32_32x32x8_bf16 v[104:119], v[32:33], v[230:231], 0
  v_exp_f32 v88, v88
  v_exp_f32 v89, v89
  v_exp_f32 v90, v90
  v_exp_f32 v91, v91
  v_mfma_f32_32x32x16_bf16 v[104:119], v[28:31], v[20:23], v[104:119]
  ds_read_b128 v[120:123], v234 offset:47616
  ds_read_b128 v[124:127], v234 offset:48384
  v_exp_f32 v92, v92
  v_exp_f32 v93, v93
  v_exp_f32 v94, v94
  v_exp_f32 v95, v95
  v_smfmac_f32_32x32x32_bf16 v[212:227], v[48:51], v[72:79], v5
  v_exp_f32 v96, v96
  v_exp_f32 v97, v97
  v_exp_f32 v98, v98
  v_exp_f32 v99, v99
  v_smfmac_f32_32x32x32_bf16 v[212:227], v[52:55], v[80:87], v5
  v_exp_f32 v100, v100
  v_exp_f32 v101, v101
  v_exp_f32 v102, v102
  v_exp_f32 v103, v103
  v_exp_f32 v104, v104
  v_exp_f32 v105, v105
  s_waitcnt lgkmcnt(2)
  v_smfmac_f32_32x32x32_bf16 v[212:227], v[128:131], v[88:95], v5
  v_exp_f32 v106, v106
  v_exp_f32 v107, v107
  v_exp_f32 v108, v108
  v_exp_f32 v109, v109
  v_smfmac_f32_32x32x32_bf16 v[212:227], v[132:135], v[96:103], v5
  v_exp_f32 v110, v110
  v_exp_f32 v111, v111
  v_exp_f32 v112, v112
  v_exp_f32 v113, v113
  s_waitcnt lgkmcnt(0)
  v_smfmac_f32_32x32x32_bf16 v[212:227], v[120:123], v[104:111], v5
  v_exp_f32 v114, v114
  v_exp_f32 v115, v115
  v_exp_f32 v116, v116
  v_exp_f32 v117, v117
  v_exp_f32 v118, v118
  v_exp_f32 v119, v119
  s_mov_b32 s49, 0
  s_setprio 1
  v_smfmac_f32_32x32x32_bf16 v[212:227], v[124:127], v[112:119], v5
  ds_read_b64_tr_b16 v[56:57], v239 offset:10240
  ds_read_b64_tr_b16 v[58:59], v240 offset:10240
  ds_read_b64_tr_b16 v[60:61], v239 offset:10248
  ds_read_b64_tr_b16 v[62:63], v240 offset:10248
  ds_read_b64_tr_b16 v[64:65], v239 offset:10256
  ds_read_b64_tr_b16 v[66:67], v240 offset:10256
  ds_read_b64_tr_b16 v[68:69], v239 offset:10264
  ds_read_b64_tr_b16 v[70:71], v240 offset:10264
  ds_read_b64_tr_b16 v[72:73], v239 offset:10272
  ds_read_b64_tr_b16 v[74:75], v240 offset:10272
  s_nop 1
  v_mov_b32 v10, v220
  v_mov_b32 v11, v220
  s_nop 1
  v_permlane32_swap_b32 v10, v11
  s_nop 1
  v_rcp_f32 v10, v11
  v_subrev_u32 v11, 0x30800000, v11
  v_cmp_lt_u32 vcc, 503316480, v11
  v_mul_f32 v212, v212, v10
  v_mul_f32 v213, v213, v10
  v_mul_f32 v214, v214, v10
  v_mul_f32 v215, v215, v10
  v_mul_f32 v216, v216, v10
  v_mul_f32 v217, v217, v10
  v_mul_f32 v218, v218, v10
  v_mul_f32 v219, v219, v10
  v_mul_f32 v220, v220, v10
  v_mul_f32 v221, v221, v10
  v_mul_f32 v222, v222, v10
  v_mul_f32 v223, v223, v10
  s_or_b64 s[26:27], vcc, s[60:61]
  v_cvt_pk_bf16_f32 v48, v212, v213
  v_cvt_pk_bf16_f32 v49, v214, v215
  v_cvt_pk_bf16_f32 v50, v216, v217
  v_cvt_pk_bf16_f32 v51, v218, v219
  v_cvt_pk_bf16_f32 v52, v220, v221
  v_cvt_pk_bf16_f32 v53, v222, v223
  s_cbranch_scc1 O_slow0
  buffer_store_dwordx4 v[48:51], v6, s[40:43], s28 offen
  s_mov_b32 exec_hi, 0
  buffer_store_dwordx2 v[52:53], v147, s[40:43], s29 offen
O_std0:
  s_mov_b64 exec, 1
  ds_add_u32 v13, v14
  s_mov_b64 exec, -1
  s_setprio 0
  ds_read_b64_tr_b16 v[76:77], v239 offset:15360
  ds_read_b64_tr_b16 v[78:79], v240 offset:15360
  ds_read_b64_tr_b16 v[80:81], v239 offset:15368
  ds_read_b64_tr_b16 v[82:83], v240 offset:15368
  ds_read_b64_tr_b16 v[84:85], v239 offset:15376
  ds_read_b64_tr_b16 v[86:87], v240 offset:15376
  ds_read_b64_tr_b16 v[88:89], v239 offset:15384
  ds_read_b64_tr_b16 v[90:91], v240 offset:15384
  ds_read_b64_tr_b16 v[92:93], v239 offset:15392
  ds_read_b64_tr_b16 v[94:95], v240 offset:15392
  ds_read_b64_tr_b16 v[96:97], v239 offset:20480
  ds_read_b64_tr_b16 v[98:99], v240 offset:20480
  ds_read_b64_tr_b16 v[100:101], v239 offset:20488
  ds_read_b64_tr_b16 v[102:103], v240 offset:20488
  ds_read_b64_tr_b16 v[104:105], v239 offset:20496
  ds_read_b64_tr_b16 v[106:107], v240 offset:20496
  ds_read_b64_tr_b16 v[108:109], v239 offset:20504
  ds_read_b64_tr_b16 v[110:111], v240 offset:20504
  ds_read_b64_tr_b16 v[112:113], v239 offset:20512
  ds_read_b64_tr_b16 v[114:115], v240 offset:20512
  s_waitcnt vmcnt(0) lgkmcnt(0)
  buffer_load_dwordx4 v[16:19], v236, s[40:43], s4 offen offset:0 sc1
  buffer_load_dwordx4 v[20:23], v236, s[40:43], s4 offen offset:2048 sc1
  buffer_load_dwordx4 v[24:27], v236, s[40:43], s5 offen offset:0 sc1
  buffer_load_dwordx4 v[28:31], v236, s[40:43], s5 offen offset:2048 sc1
  buffer_load_dwordx2 v[32:33], v237, s[40:43], s4 offen sc1
  buffer_load_dwordx2 v[34:35], v237, s[40:43], s4 offen offset:256 sc1
  buffer_load_dwordx4 v[36:39], v236, s[40:43], s6 offen offset:0 sc1
  buffer_load_dwordx4 v[40:43], v236, s[40:43], s6 offen offset:2048 sc1
  buffer_load_dwordx4 v[44:47], v236, s[40:43], s7 offen offset:0 sc1
  buffer_load_dwordx4 v[48:51], v236, s[40:43], s7 offen offset:2048 sc1
  buffer_load_dwordx2 v[52:53], v237, s[40:43], s6 offen sc1
  buffer_load_dwordx2 v[54:55], v237, s[40:43], s6 offen offset:256 sc1
  ds_read_b64_tr_b16 v[116:117], v239 offset:25600
  ds_read_b64_tr_b16 v[118:119], v240 offset:25600
  ds_read_b64_tr_b16 v[120:121], v239 offset:25608
  ds_read_b64_tr_b16 v[122:123], v240 offset:25608
  ds_read_b64_tr_b16 v[124:125], v239 offset:25616
  ds_read_b64_tr_b16 v[126:127], v240 offset:25616
  ds_read_b64_tr_b16 v[128:129], v239 offset:25624
  ds_read_b64_tr_b16 v[130:131], v240 offset:25624
  ds_read_b64_tr_b16 v[132:133], v239 offset:25632
  ds_read_b64_tr_b16 v[134:135], v240 offset:25632
  ds_read_b64_tr_b16 v[136:137], v239 offset:30720
  ds_read_b64_tr_b16 v[138:139], v240 offset:30720
  ds_read_b64_tr_b16 v[140:141], v239 offset:30728
  ds_read_b64_tr_b16 v[142:143], v240 offset:30728
  ds_read_b64_tr_b16 v[144:145], v239 offset:30736
  ds_read_b64_tr_b16 v[146:147], v240 offset:30736
  ds_read_b64_tr_b16 v[148:149], v239 offset:30744
  ds_read_b64_tr_b16 v[150:151], v240 offset:30744
  ds_read_b64_tr_b16 v[152:153], v239 offset:30752
  ds_read_b64_tr_b16 v[154:155], v240 offset:30752
  ds_read_b64_tr_b16 v[196:197], v239 offset:35840
  ds_read_b64_tr_b16 v[198:199], v240 offset:35840
  ds_read_b64_tr_b16 v[200:201], v239 offset:35848
  ds_read_b64_tr_b16 v[202:203], v240 offset:35848
  ds_read_b64_tr_b16 v[204:205], v239 offset:35856
  ds_read_b64_tr_b16 v[206:207], v240 offset:35856
  ds_read_b64_tr_b16 v[208:209], v239 offset:35864
  ds_read_b64_tr_b16 v[210:211], v240 offset:35864
  ds_read_b64_tr_b16 v[212:213], v239 offset:35872
  ds_read_b64_tr_b16 v[214:215], v240 offset:35872
  s_waitcnt vmcnt(11)
  v_max3_u32 v7, v16, v17, v18
  v_max_u32 v7, v7, v19
  v_cmp_eq_u32 vcc, -1, v7
  s_nop 0
  s_cbranch_vccnz O_c00_r
O_c00_ok:
  v_mfma_f32_16x16x32_bf16 v[216:219], v[156:159], v[16:19], 0
  s_waitcnt vmcnt(10)
  v_max3_u32 v7, v20, v21, v22
  v_mfma_f32_16x16x32_bf16 v[220:223], v[160:163], v[16:19], 0
  v_max_u32 v7, v7, v23
  v_mfma_f32_16x16x32_bf16 v[224:227], v[164:167], v[16:19], 0
  v_cmp_eq_u32 vcc, -1, v7
  v_mfma_f32_16x16x32_bf16 v[228:231], v[168:171], v[16:19], 0
  v_mfma_f32_16x16x32_bf16 v[232:235], v[172:175], v[16:19], 0
  s_cbranch_vccnz O_c10_r
O_c10_ok:
  v_mfma_f32_16x16x32_bf16 v[216:219], v[176:179], v[20:23], v[216:219]
  ds_read_b64_tr_b16 v[156:157], v239 offset:40960
  s_waitcnt vmcnt(9)
  v_max3_u32 v7, v24, v25, v26
  v_mfma_f32_16x16x32_bf16 v[220:223], v[180:183], v[20:23], v[220:223]
  ds_read_b64_tr_b16 v[158:159], v240 offset:40960
  v_max_u32 v7, v7, v27
  v_mfma_f32_16x16x32_bf16 v[224:227], v[184:187], v[20:23], v[224:227]
  ds_read_b64_tr_b16 v[160:161], v239 offset:40968
  v_cmp_eq_u32 vcc, -1, v7
  v_mfma_f32_16x16x32_bf16 v[228:231], v[188:191], v[20:23], v[228:231]
  ds_read_b64_tr_b16 v[162:163], v240 offset:40968
  v_mfma_f32_16x16x32_bf16 v[232:235], v[192:195], v[20:23], v[232:235]
  ds_read_b64_tr_b16 v[164:165], v239 offset:40976
  s_cbranch_vccnz O_c20_r
O_c20_ok:
  v_mfma_f32_16x16x32_bf16 v[216:219], v[56:59], v[24:27], v[216:219]
  ds_read_b64_tr_b16 v[166:167], v240 offset:40976
  s_waitcnt vmcnt(8)
  v_max3_u32 v7, v28, v29, v30
  v_mfma_f32_16x16x32_bf16 v[220:223], v[60:63], v[24:27], v[220:223]
  ds_read_b64_tr_b16 v[168:169], v239 offset:40984
  v_max_u32 v7, v7, v31
  v_mfma_f32_16x16x32_bf16 v[224:227], v[64:67], v[24:27], v[224:227]
  ds_read_b64_tr_b16 v[170:171], v240 offset:40984
  v_cmp_eq_u32 vcc, -1, v7
  v_mfma_f32_16x16x32_bf16 v[228:231], v[68:71], v[24:27], v[228:231]
  ds_read_b64_tr_b16 v[172:173], v239 offset:40992
  v_mfma_f32_16x16x32_bf16 v[232:235], v[72:75], v[24:27], v[232:235]
  ds_read_b64_tr_b16 v[174:175], v240 offset:40992
  s_cbranch_vccnz O_c30_r
O_c30_ok:
  v_mfma_f32_16x16x32_bf16 v[216:219], v[76:79], v[28:31], v[216:219]
  ds_read_b64_tr_b16 v[176:177], v239 offset:46080
  s_waitcnt vmcnt(6)
  v_max3_u32 v7, v32, v33, v34
  v_mfma_f32_16x16x32_bf16 v[220:223], v[80:83], v[28:31], v[220:223]
  ds_read_b64_tr_b16 v[178:179], v240 offset:46080
  v_max_u32 v7, v7, v35
  v_mfma_f32_16x16x32_bf16 v[224:227], v[84:87], v[28:31], v[224:227]
  ds_read_b64_tr_b16 v[180:181], v239 offset:46088
  v_cmp_eq_u32 vcc, -1, v7
  v_mfma_f32_16x16x32_bf16 v[228:231], v[88:91], v[28:31], v[228:231]
  ds_read_b64_tr_b16 v[182:183], v240 offset:46088
  v_mfma_f32_16x16x32_bf16 v[232:235], v[92:95], v[28:31], v[232:235]
  ds_read_b64_tr_b16 v[184:185], v239 offset:46096
  s_cbranch_vccnz O_c40_r
O_c40_ok:
  v_mfma_f32_16x16x32_bf16 v[216:219], v[96:99], v[32:35], v[216:219]
  ds_read_b64_tr_b16 v[186:187], v240 offset:46096
  s_waitcnt vmcnt(5)
  v_max3_u32 v7, v36, v37, v38
  v_mfma_f32_16x16x32_bf16 v[220:223], v[100:103], v[32:35], v[220:223]
  ds_read_b64_tr_b16 v[188:189], v239 offset:46104
  v_max_u32 v7, v7, v39
  v_mfma_f32_16x16x32_bf16 v[224:227], v[104:107], v[32:35], v[224:227]
  ds_read_b64_tr_b16 v[190:191], v240 offset:46104
  v_cmp_eq_u32 vcc, -1, v7
  v_mfma_f32_16x16x32_bf16 v[228:231], v[108:111], v[32:35], v[228:231]
  ds_read_b64_tr_b16 v[192:193], v239 offset:46112
  v_mfma_f32_16x16x32_bf16 v[232:235], v[112:115], v[32:35], v[232:235]
  ds_read_b64_tr_b16 v[194:195], v240 offset:46112
  s_cbranch_vccnz O_c50_r
O_c50_ok:
  s_waitcnt lgkmcnt(14)
  v_mfma_f32_16x16x32_bf16 v[216:219], v[116:119], v[36:39], v[216:219]
  s_waitcnt vmcnt(4)
  v_max3_u32 v7, v40, v41, v42
  v_mfma_f32_16x16x32_bf16 v[220:223], v[120:123], v[36:39], v[220:223]
  v_max_u32 v7, v7, v43
  v_mfma_f32_16x16x32_bf16 v[224:227], v[124:127], v[36:39], v[224:227]
  v_cmp_eq_u32 vcc, -1, v7
  v_mfma_f32_16x16x32_bf16 v[228:231], v[128:131], v[36:39], v[228:231]
  v_mfma_f32_16x16x32_bf16 v[232:235], v[132:135], v[36:39], v[232:235]
  s_cbranch_vccnz O_c60_r
O_c60_ok:
  v_mfma_f32_16x16x32_bf16 v[216:219], v[136:139], v[40:43], v[216:219]
  s_waitcnt vmcnt(3)
  v_max3_u32 v7, v44, v45, v46
  v_mfma_f32_16x16x32_bf16 v[220:223], v[140:143], v[40:43], v[220:223]
  v_max_u32 v7, v7, v47
  v_mfma_f32_16x16x32_bf16 v[224:227], v[144:147], v[40:43], v[224:227]
  v_cmp_eq_u32 vcc, -1, v7
  v_mfma_f32_16x16x32_bf16 v[228:231], v[148:151], v[40:43], v[228:231]
  v_mfma_f32_16x16x32_bf16 v[232:235], v[152:155], v[40:43], v[232:235]
  s_cbranch_vccnz O_c70_r
O_c70_ok:
  v_mfma_f32_16x16x32_bf16 v[216:219], v[196:199], v[44:47], v[216:219]
  s_waitcnt vmcnt(2)
  v_max3_u32 v7, v48, v49, v50
  v_mfma_f32_16x16x32_bf16 v[220:223], v[200:203], v[44:47], v[220:223]
  v_max_u32 v7, v7, v51
  v_mfma_f32_16x16x32_bf16 v[224:227], v[204:207], v[44:47], v[224:227]
  v_cmp_eq_u32 vcc, -1, v7
  v_mfma_f32_16x16x32_bf16 v[228:231], v[208:211], v[44:47], v[228:231]
  v_mfma_f32_16x16x32_bf16 v[232:235], v[212:215], v[44:47], v[232:235]
  s_cbranch_vccnz O_c80_r
O_c80_ok:
  s_waitcnt lgkmcnt(10)
  v_mfma_f32_16x16x32_bf16 v[216:219], v[156:159], v[48:51], v[216:219]
  ds_read_b32 v8, v13
  s_waitcnt vmcnt(0)
  v_max3_u32 v7, v52, v53, v54
  v_mfma_f32_16x16x32_bf16 v[220:223], v[160:163], v[48:51], v[220:223]
  v_max_u32 v7, v7, v55
  v_mfma_f32_16x16x32_bf16 v[224:227], v[164:167], v[48:51], v[224:227]
  v_cmp_eq_u32 vcc, -1, v7
  v_mfma_f32_16x16x32_bf16 v[228:231], v[168:171], v[48:51], v[228:231]
  v_mfma_f32_16x16x32_bf16 v[232:235], v[172:175], v[48:51], v[232:235]
  s_cbranch_vccnz O_c90_r
O_c90_ok:
  s_waitcnt lgkmcnt(1)
  v_mfma_f32_16x16x32_bf16 v[216:219], v[176:179], v[52:55], v[216:219]
  v_mfma_f32_16x16x32_bf16 v[220:223], v[180:183], v[52:55], v[220:223]
  v_mfma_f32_16x16x32_bf16 v[224:227], v[184:187], v[52:55], v[224:227]
  v_mfma_f32_16x16x32_bf16 v[228:231], v[188:191], v[52:55], v[228:231]
  v_mfma_f32_16x16x32_bf16 v[232:235], v[192:195], v[52:55], v[232:235]
  s_waitcnt lgkmcnt(0)
  v_readfirstlane_b32 s25, v8
  s_cmp_eq_u32 s25, s36
  s_cbranch_scc0 O_kr
O_kok:
  ds_write_b128 v238, v[216:219] offset:0
  ds_write_b128 v238, v[220:223] offset:1024
  ds_write_b128 v238, v[224:227] offset:2048
  ds_write_b128 v238, v[228:231] offset:3072
  ds_write_b128 v238, v[232:235] offset:4096
  s_mov_b64 exec, 1
  ds_write_b32 v12, v5
  s_waitcnt lgkmcnt(0)
  s_or_b32 s25, s2, s22
  s_cbranch_scc1 O_end0
  s_mov_b32 s27, 294912
  v_mov_b32 v1, s62
  buffer_store_dword v1, off, s[40:43], s27 sc1
O_end0:
L_end:
  s_endpgm
.p2align 12
L_hlp:
  s_waitcnt lgkmcnt(0)
  s_load_dword s62, s[18:19], 294912
  s_waitcnt lgkmcnt(0)
  s_add_u32 s62, s62, 0x9e3779b0
  s_andn2_b32 s62, s62, 15
  s_mov_b32 s63, s62
  s_cmp_eq_u32 s48, 2
  s_cbranch_scc1 L_setup
  s_barrier
  s_branch L_setup
L_nu0:
  v_lshlrev_b32 v2, 2, v0
  v_add_u32 v2, 163328, v2
  ds_write_b32 v2, v7
  s_mov_b32 s32, s6
  s_and_b32 s33, s7, 0xffff
  s_waitcnt lgkmcnt(0)
  s_barrier
  s_mov_b32 m0, 0
  s_mov_b32 s52, 0
  buffer_load_dwordx4 v16, s[32:35], s52 offen offset:0 lds
  buffer_load_dwordx4 v17, s[32:35], s52 offen offset:1024 lds
  buffer_load_dwordx4 v18, s[32:35], s52 offen offset:2048 lds
  buffer_load_dwordx4 v19, s[32:35], s52 offen offset:3072 lds
  s_mov_b32 m0, 4096
  s_nop 0
  buffer_load_dwordx4 v20, s[32:35], s52 offen offset:0 lds
  s_mov_b32 m0, 163324
  s_mov_b64 exec, 1
  global_load_lds_dword v7, s[8:9] offset:4
  s_mov_b64 exec, -1
  s_mov_b32 m0, 5120
  s_mov_b32 s52, 40960
  buffer_load_dwordx4 v16, s[32:35], s52 offen offset:0 lds
  buffer_load_dwordx4 v17, s[32:35], s52 offen offset:1024 lds
  buffer_load_dwordx4 v18, s[32:35], s52 offen offset:2048 lds
  buffer_load_dwordx4 v19, s[32:35], s52 offen offset:3072 lds
  s_mov_b32 m0, 9216
  s_nop 0
  buffer_load_dwordx4 v20, s[32:35], s52 offen offset:0 lds
  s_mov_b32 m0, 163320
  s_mov_b64 exec, 1
  global_load_lds_dword v7, s[8:9] offset:8
  s_mov_b64 exec, -1
  s_branch L_midd
L_mids:
  s_cmp_eq_u32 s48, 2
  s_cbranch_scc0 L_midd
  s_barrier
  s_branch L_midd
L_hlp2:
  s_cmp_eq_u32 s48, 2
  s_cbranch_scc0 L_b2
  s_mov_b32 s32, s6
  s_and_b32 s33, s7, 0xffff
  s_getpc_b64 s[8:9]
L_dpc1:
  s_add_u32 s8, s8, L_tbl-L_dpc1
  s_addc_u32 s9, s9, 0
  v_mov_b32 v7, 0
  v_min_u32 v8, 1920, v144
  s_lshl_b32 s10, s3, 10
  v_xor_b32 v8, s10, v8
  s_mov_b32 s10, 262144
  s_lshl_b32 s11, s3, 15
  s_add_u32 s11, s11, 524288
  v_and_b32 v9, 896, v144
  s_lshl_b32 s25, s3, 10
  s_add_u32 s26, s25, 524288
  v_add_u32 v11, s25, v9
  v_add_u32 v9, s26, v9
  v_cmp_gt_u32 vcc, 8, v0
  s_or_b32 s54, s62, s16
  v_cndmask_b32 v11, v11, v9, vcc
  s_mul_i32 s27, s17, 12800
  s_add_u32 s27, s27, 409600
  v_min_u32 v4, 6272, v144
  s_mov_b32 s51, 0
  s_mov_b32 s58, 0
  s_setprio 0
  s_cmp_ge_u32 s51, 3212836865
  s_cbranch_scc0 S_n24
L_n24:
  s_mov_b32 m0, 10240
  s_mov_b32 s52, 81920
  buffer_load_dwordx4 v16, s[32:35], s52 offen offset:0 lds
  buffer_load_dwordx4 v17, s[32:35], s52 offen offset:1024 lds
  buffer_load_dwordx4 v18, s[32:35], s52 offen offset:2048 lds
  buffer_load_dwordx4 v19, s[32:35], s52 offen offset:3072 lds
  s_mov_b32 m0, 14336
  s_nop 0
  buffer_load_dwordx4 v20, s[32:35], s52 offen offset:0 lds
  s_mov_b32 m0, 163320
  s_mov_b64 exec, 1
  global_load_lds_dword v7, s[8:9] offset:12
  s_mov_b64 exec, -1
  s_mov_b32 m0, 15360
  s_mov_b32 s52, 122880
  buffer_load_dwordx4 v16, s[32:35], s52 offen offset:0 lds
  buffer_load_dwordx4 v17, s[32:35], s52 offen offset:1024 lds
  buffer_load_dwordx4 v18, s[32:35], s52 offen offset:2048 lds
  buffer_load_dwordx4 v19, s[32:35], s52 offen offset:3072 lds
  s_mov_b32 m0, 19456
  s_nop 0
  buffer_load_dwordx4 v20, s[32:35], s52 offen offset:0 lds
  s_mov_b32 m0, 163316
  s_mov_b64 exec, 1
  global_load_lds_dword v7, s[8:9] offset:16
  s_mov_b64 exec, -1
  s_mov_b32 m0, 20480
  s_mov_b32 s52, 163840
  buffer_load_dwordx4 v16, s[32:35], s52 offen offset:0 lds
  buffer_load_dwordx4 v17, s[32:35], s52 offen offset:1024 lds
  buffer_load_dwordx4 v18, s[32:35], s52 offen offset:2048 lds
  buffer_load_dwordx4 v19, s[32:35], s52 offen offset:3072 lds
  s_mov_b32 m0, 24576
  s_nop 0
  buffer_load_dwordx4 v20, s[32:35], s52 offen offset:0 lds
  s_mov_b32 m0, 163312
  s_mov_b64 exec, 1
  global_load_lds_dword v7, s[8:9] offset:20
  s_mov_b64 exec, -1
  s_mov_b32 m0, 25600
  s_mov_b32 s52, 204800
  buffer_load_dwordx4 v16, s[32:35], s52 offen offset:0 lds
  buffer_load_dwordx4 v17, s[32:35], s52 offen offset:1024 lds
  buffer_load_dwordx4 v18, s[32:35], s52 offen offset:2048 lds
  buffer_load_dwordx4 v19, s[32:35], s52 offen offset:3072 lds
  s_mov_b32 m0, 29696
  s_nop 0
  buffer_load_dwordx4 v20, s[32:35], s52 offen offset:0 lds
  s_mov_b32 m0, 163308
  s_mov_b64 exec, 1
  global_load_lds_dword v7, s[8:9] offset:24
  s_mov_b64 exec, -1
  s_mov_b32 m0, 30720
  s_mov_b32 s52, 245760
  buffer_load_dwordx4 v16, s[32:35], s52 offen offset:0 lds
  buffer_load_dwordx4 v17, s[32:35], s52 offen offset:1024 lds
  buffer_load_dwordx4 v18, s[32:35], s52 offen offset:2048 lds
  buffer_load_dwordx4 v19, s[32:35], s52 offen offset:3072 lds
  s_mov_b32 m0, 34816
  s_nop 0
  buffer_load_dwordx4 v20, s[32:35], s52 offen offset:0 lds
  s_mov_b32 m0, 163304
  s_mov_b64 exec, 1
  global_load_lds_dword v7, s[8:9] offset:28
  s_mov_b64 exec, -1
  ds_read_b32 v10, v152 offset:32
  s_mov_b32 m0, 35840
  s_mov_b32 s52, 286720
  buffer_load_dwordx4 v16, s[32:35], s52 offen offset:0 lds
  buffer_load_dwordx4 v17, s[32:35], s52 offen offset:1024 lds
  buffer_load_dwordx4 v18, s[32:35], s52 offen offset:2048 lds
  buffer_load_dwordx4 v19, s[32:35], s52 offen offset:3072 lds
  s_mov_b32 m0, 39936
  s_nop 0
  buffer_load_dwordx4 v20, s[32:35], s52 offen offset:0 lds
  s_mov_b32 m0, 163300
  s_mov_b64 exec, 1
  global_load_lds_dword v7, s[8:9] offset:32
  s_mov_b64 exec, -1
  s_waitcnt lgkmcnt(0)
  v_readfirstlane_b32 s58, v10
  s_cmp_eq_u32 s58, 2004318068
  s_cbranch_scc0 S_n25
L_n25:
  s_mov_b32 m0, 40960
  s_mov_b32 s52, 327680
  buffer_load_dwordx4 v16, s[32:35], s52 offen offset:0 lds
  buffer_load_dwordx4 v17, s[32:35], s52 offen offset:1024 lds
  buffer_load_dwordx4 v18, s[32:35], s52 offen offset:2048 lds
  buffer_load_dwordx4 v19, s[32:35], s52 offen offset:3072 lds
  s_mov_b32 m0, 45056
  s_nop 0
  buffer_load_dwordx4 v20, s[32:35], s52 offen offset:0 lds
  s_mov_b32 m0, 163296
  s_mov_b64 exec, 1
  global_load_lds_dword v7, s[8:9] offset:36
  s_mov_b64 exec, -1
  s_waitcnt vmcnt(36)
  s_mov_b32 m0, 46080
  s_mov_b32 s52, 368640
  buffer_load_dwordx4 v16, s[32:35], s52 offen offset:0 lds
  buffer_load_dwordx4 v17, s[32:35], s52 offen offset:1024 lds
  buffer_load_dwordx4 v18, s[32:35], s52 offen offset:2048 lds
  buffer_load_dwordx4 v19, s[32:35], s52 offen offset:3072 lds
  s_mov_b32 m0, 50176
  s_nop 0
  buffer_load_dwordx4 v20, s[32:35], s52 offen offset:0 lds
  s_mov_b32 m0, 163292
  s_mov_b64 exec, 1
  global_load_lds_dword v7, s[8:9] offset:40
  s_mov_b64 exec, -1
  s_waitcnt vmcnt(36)
  s_mov_b32 m0, 51200
  s_mov_b32 s52, 409600
  buffer_load_dwordx4 v16, s[32:35], s52 offen offset:0 lds
  buffer_load_dwordx4 v17, s[32:35], s52 offen offset:1024 lds
  buffer_load_dwordx4 v18, s[32:35], s52 offen offset:2048 lds
  buffer_load_dwordx4 v19, s[32:35], s52 offen offset:3072 lds
  s_mov_b32 m0, 55296
  s_nop 0
  buffer_load_dwordx4 v20, s[32:35], s52 offen offset:0 lds
  s_mov_b32 m0, 163288
  s_mov_b64 exec, 1
  global_load_lds_dword v7, s[8:9] offset:44
  s_mov_b64 exec, -1
  s_waitcnt vmcnt(36)
  ds_read_b32 v10, v152 offset:36
  s_mov_b32 m0, 56320
  s_mov_b32 s52, 450560
  buffer_load_dwordx4 v16, s[32:35], s52 offen offset:0 lds
  buffer_load_dwordx4 v17, s[32:35], s52 offen offset:1024 lds
  buffer_load_dwordx4 v18, s[32:35], s52 offen offset:2048 lds
  buffer_load_dwordx4 v19, s[32:35], s52 offen offset:3072 lds
  s_mov_b32 m0, 60416
  s_nop 0
  buffer_load_dwordx4 v20, s[32:35], s52 offen offset:0 lds
  s_mov_b32 m0, 163284
  s_mov_b64 exec, 1
  global_load_lds_dword v7, s[8:9] offset:48
  s_mov_b64 exec, -1
  s_waitcnt vmcnt(36)
  s_waitcnt lgkmcnt(0)
  v_readfirstlane_b32 s58, v10
  s_cmp_eq_u32 s58, 2004318068
  s_cbranch_scc0 S_n26
L_n26:
  s_mov_b32 m0, 61440
  s_mov_b32 s52, 491520
  buffer_load_dwordx4 v16, s[32:35], s52 offen offset:0 lds
  buffer_load_dwordx4 v17, s[32:35], s52 offen offset:1024 lds
  buffer_load_dwordx4 v18, s[32:35], s52 offen offset:2048 lds
  buffer_load_dwordx4 v19, s[32:35], s52 offen offset:3072 lds
  s_mov_b32 m0, 65536
  s_nop 0
  buffer_load_dwordx4 v20, s[32:35], s52 offen offset:0 lds
  s_mov_b32 m0, 163280
  s_mov_b64 exec, 1
  global_load_lds_dword v7, s[8:9] offset:52
  s_mov_b64 exec, -1
  s_waitcnt vmcnt(36)
  s_mov_b32 m0, 66560
  s_mov_b32 s52, 532480
  buffer_load_dwordx4 v16, s[32:35], s52 offen offset:0 lds
  buffer_load_dwordx4 v17, s[32:35], s52 offen offset:1024 lds
  buffer_load_dwordx4 v18, s[32:35], s52 offen offset:2048 lds
  buffer_load_dwordx4 v19, s[32:35], s52 offen offset:3072 lds
  s_mov_b32 m0, 70656
  s_nop 0
  buffer_load_dwordx4 v20, s[32:35], s52 offen offset:0 lds
  s_mov_b32 m0, 163276
  s_mov_b64 exec, 1
  global_load_lds_dword v7, s[8:9] offset:56
  s_mov_b64 exec, -1
  s_waitcnt vmcnt(36)
  s_mov_b32 m0, 71680
  s_mov_b32 s52, 573440
  buffer_load_dwordx4 v16, s[32:35], s52 offen offset:0 lds
  buffer_load_dwordx4 v17, s[32:35], s52 offen offset:1024 lds
  buffer_load_dwordx4 v18, s[32:35], s52 offen offset:2048 lds
  buffer_load_dwordx4 v19, s[32:35], s52 offen offset:3072 lds
  s_mov_b32 m0, 75776
  s_nop 0
  buffer_load_dwordx4 v20, s[32:35], s52 offen offset:0 lds
  s_mov_b32 m0, 163272
  s_mov_b64 exec, 1
  global_load_lds_dword v7, s[8:9] offset:60
  s_mov_b64 exec, -1
  s_waitcnt vmcnt(36)
  s_mov_b32 m0, 76800
  s_mov_b32 s52, 614400
  buffer_load_dwordx4 v16, s[32:35], s52 offen offset:0 lds
  buffer_load_dwordx4 v17, s[32:35], s52 offen offset:1024 lds
  buffer_load_dwordx4 v18, s[32:35], s52 offen offset:2048 lds
  buffer_load_dwordx4 v19, s[32:35], s52 offen offset:3072 lds
  s_mov_b32 m0, 80896
  s_nop 0
  buffer_load_dwordx4 v20, s[32:35], s52 offen offset:0 lds
  s_mov_b32 m0, 163268
  s_mov_b64 exec, 1
  global_load_lds_dword v7, s[8:9] offset:64
  s_mov_b64 exec, -1
  s_waitcnt vmcnt(36)
  ds_read_b32 v10, v152 offset:40
  s_mov_b32 m0, 81920
  s_mov_b32 s52, 655360
  buffer_load_dwordx4 v16, s[32:35], s52 offen offset:0 lds
  buffer_load_dwordx4 v17, s[32:35], s52 offen offset:1024 lds
  buffer_load_dwordx4 v18, s[32:35], s52 offen offset:2048 lds
  buffer_load_dwordx4 v19, s[32:35], s52 offen offset:3072 lds
  s_mov_b32 m0, 86016
  s_nop 0
  buffer_load_dwordx4 v20, s[32:35], s52 offen offset:0 lds
  s_mov_b32 m0, 163264
  s_mov_b64 exec, 1
  global_load_lds_dword v7, s[8:9] offset:68
  s_mov_b64 exec, -1
  s_waitcnt vmcnt(36)
  s_waitcnt lgkmcnt(0)
  v_readfirstlane_b32 s58, v10
  s_cmp_eq_u32 s58, 2004318068
  s_cbranch_scc0 S_n27
L_n27:
  buffer_load_dwordx4 v[148:151], v9, s[40:43], s10 offen sc1
  s_mov_b32 m0, 87040
  s_mov_b32 s52, 696320
  buffer_load_dwordx4 v16, s[32:35], s52 offen offset:0 lds
  buffer_load_dwordx4 v17, s[32:35], s52 offen offset:1024 lds
  buffer_load_dwordx4 v18, s[32:35], s52 offen offset:2048 lds
  buffer_load_dwordx4 v19, s[32:35], s52 offen offset:3072 lds
  s_mov_b32 m0, 91136
  s_nop 0
  buffer_load_dwordx4 v20, s[32:35], s52 offen offset:0 lds
  s_mov_b32 m0, 163260
  s_mov_b64 exec, 1
  global_load_lds_dword v7, s[8:9] offset:72
  s_mov_b64 exec, -1
  s_waitcnt vmcnt(36)
  s_mov_b32 m0, 92160
  s_mov_b32 s52, 737280
  buffer_load_dwordx4 v16, s[32:35], s52 offen offset:0 lds
  buffer_load_dwordx4 v17, s[32:35], s52 offen offset:1024 lds
  buffer_load_dwordx4 v18, s[32:35], s52 offen offset:2048 lds
  buffer_load_dwordx4 v19, s[32:35], s52 offen offset:3072 lds
  s_mov_b32 m0, 96256
  s_nop 0
  buffer_load_dwordx4 v20, s[32:35], s52 offen offset:0 lds
  s_mov_b32 m0, 163256
  s_mov_b64 exec, 1
  global_load_lds_dword v7, s[8:9] offset:76
  s_mov_b64 exec, -1
  s_waitcnt vmcnt(36)
  s_mov_b32 m0, 97280
  s_mov_b32 s52, 778240
  buffer_load_dwordx4 v16, s[32:35], s52 offen offset:0 lds
  buffer_load_dwordx4 v17, s[32:35], s52 offen offset:1024 lds
  buffer_load_dwordx4 v18, s[32:35], s52 offen offset:2048 lds
  buffer_load_dwordx4 v19, s[32:35], s52 offen offset:3072 lds
  s_mov_b32 m0, 101376
  s_nop 0
  buffer_load_dwordx4 v20, s[32:35], s52 offen offset:0 lds
  s_mov_b32 m0, 163252
  s_mov_b64 exec, 1
  global_load_lds_dword v7, s[8:9] offset:80
  s_mov_b64 exec, -1
  s_mov_b32 s58, 0
  s_waitcnt vmcnt(18)
L_pp:
  v_xor_b32 v1, s54, v148
  v_xor_b32 v2, s54, v149
  v_xor_b32 v3, s54, v150
  v_xor_b32 v4, s54, v151
  v_or3_b32 v1, v1, v2, v3
  v_or_b32 v1, v1, v4
  v_cmp_lt_u32 vcc, 0, v1
  s_nop 3
  s_and_b32 s25, vcc_lo, 255
  s_cbranch_scc1 S_pp
L_pgo:
  s_mov_b32 m0, 102400
  s_add_u32 s25, s11, 0
  buffer_load_dwordx4 v6, s[40:43], s25 offen offset:0 sc1 lds
  buffer_load_dwordx4 v6, s[40:43], s25 offen offset:1024 sc1 lds
  buffer_load_dwordx4 v6, s[40:43], s25 offen offset:2048 sc1 lds
  s_mov_b32 m0, 114688
  s_add_u32 s25, s11, 12288
  buffer_load_dwordx4 v6, s[40:43], s25 offen offset:0 sc1 lds
  buffer_load_dwordx4 v6, s[40:43], s25 offen offset:1024 sc1 lds
  buffer_load_dwordx4 v6, s[40:43], s25 offen offset:2048 sc1 lds
  s_mov_b32 m0, 105472
  s_add_u32 s25, s11, 3072
  buffer_load_dwordx4 v6, s[40:43], s25 offen offset:0 sc1 lds
  buffer_load_dwordx4 v6, s[40:43], s25 offen offset:1024 sc1 lds
  buffer_load_dwordx4 v6, s[40:43], s25 offen offset:2048 sc1 lds
  s_mov_b32 m0, 117760
  s_add_u32 s25, s11, 15360
  buffer_load_dwordx4 v6, s[40:43], s25 offen offset:0 sc1 lds
  buffer_load_dwordx4 v6, s[40:43], s25 offen offset:1024 sc1 lds
  buffer_load_dwordx4 v6, s[40:43], s25 offen offset:2048 sc1 lds
  s_mov_b32 m0, 108544
  s_add_u32 s25, s11, 6144
  buffer_load_dwordx4 v6, s[40:43], s25 offen offset:0 sc1 lds
  buffer_load_dwordx4 v6, s[40:43], s25 offen offset:1024 sc1 lds
  buffer_load_dwordx4 v6, s[40:43], s25 offen offset:2048 sc1 lds
  s_mov_b32 m0, 120832
  s_add_u32 s25, s11, 18432
  buffer_load_dwordx4 v6, s[40:43], s25 offen offset:0 sc1 lds
  buffer_load_dwordx4 v6, s[40:43], s25 offen offset:1024 sc1 lds
  buffer_load_dwordx4 v6, s[40:43], s25 offen offset:2048 sc1 lds
  s_mov_b32 m0, 111616
  s_add_u32 s25, s11, 9216
  buffer_load_dwordx4 v6, s[40:43], s25 offen offset:0 sc1 lds
  buffer_load_dwordx4 v6, s[40:43], s25 offen offset:1024 sc1 lds
  buffer_load_dwordx4 v6, s[40:43], s25 offen offset:2048 sc1 lds
  s_mov_b32 m0, 123904
  s_add_u32 s25, s11, 21504
  buffer_load_dwordx4 v6, s[40:43], s25 offen offset:0 sc1 lds
  buffer_load_dwordx4 v6, s[40:43], s25 offen offset:1024 sc1 lds
  buffer_load_dwordx4 v6, s[40:43], s25 offen offset:2048 sc1 lds
  v_or_b32 v8, 1024, v144
  v_min_u32 v8, 1920, v8
  s_lshl_b32 s25, s3, 10
  v_xor_b32 v8, s25, v8
  s_waitcnt vmcnt(24)
  buffer_load_dwordx4 v[148:151], v8, s[40:43], s10 offen sc1
  s_mov_b32 s32, s12
  s_and_b32 s33, s13, 0xffff
  s_mul_i32 s25, s2, 3200
  v_min_u32 v1, 3072, v144
  buffer_load_dword v235, v1, s[32:35], s25 offen
  s_mov_b32 s11, s54
  s_mov_b32 s32, s12
  s_and_b32 s33, s13, 0xffff
  s_and_b32 s56, s23, 1
  s_lshl_b32 s56, s56, 3
  s_lshr_b32 s57, s23, 1
  s_add_u32 s56, s56, s57
  s_mul_i32 s56, s56, 51200
  s_mul_i32 s57, s23, 25600
  s_mul_i32 s25, s24, 102400
  s_add_u32 s52, s56, s25
  s_add_u32 s54, s52, 204800
  s_mul_i32 s25, s24, 5120
  s_add_u32 s53, s57, s25
  s_add_u32 s55, s53, 10240
  s_lshl_b32 s25, s24, 11
  s_add_u32 s57, s57, s25
  s_add_u32 s57, s57, 20480
  s_lshl_b32 s26, s20, 2
  s_and_b32 s27, s23, 2
  s_add_u32 s26, s26, s27
  s_add_u32 s26, s26, s24
  s_mul_i32 s26, s26, 20480
  s_add_u32 s4, s26, 1048576
  s_lshr_b32 s27, s21, 1
  s_mul_i32 s27, s27, 5120
  s_add_u32 s26, s4, s27
  s_and_b32 s5, s21, 1
  s_and_b32 s6, s23, 1
  s_lshl1_add_u32 s5, s5, s6
  s_lshl_b32 s28, s5, 10
  s_add_u32 s28, s28, s26
  s_lshl_b32 s29, s5, 8
  s_add_u32 s29, s29, s26
  s_add_u32 s29, s29, 4096
  s_mul_i32 s30, s5, -768
  s_add_u32 s30, s30, 3072
  s_add_u32 s5, s4, 5120
  s_add_u32 s6, s4, 10240
  s_add_u32 s7, s4, 15360
  s_mov_b32 s36, 8
  s_waitcnt vmcnt(1)
  v_xor_b32 v1, s11, v148
  v_xor_b32 v2, s11, v149
  v_xor_b32 v3, s11, v150
  v_xor_b32 v4, s11, v151
  v_or3_b32 v1, v1, v2, v3
  v_or_b32 v1, v1, v4
  v_cmp_lt_u32 vcc, 15, v1
  s_nop 3
  v_mov_b32 v1, vcc_lo
  v_and_b32 v1, 0xff00, v1
  s_mov_b64 exec, 1
  ds_write_b32 v152, v1 offset:12
  s_mov_b64 exec, -1
  s_setprio 0
  s_branch L_b2b
L_b2:
  s_mov_b32 s32, s12
  s_and_b32 s33, s13, 0xffff
  s_and_b32 s56, s23, 1
  s_lshl_b32 s56, s56, 3
  s_lshr_b32 s57, s23, 1
  s_add_u32 s56, s56, s57
  s_mul_i32 s56, s56, 51200
  s_mul_i32 s57, s23, 25600
  s_mul_i32 s25, s24, 102400
  s_add_u32 s52, s56, s25
  s_add_u32 s54, s52, 204800
  s_mul_i32 s25, s24, 5120
  s_add_u32 s53, s57, s25
  s_add_u32 s55, s53, 10240
  s_lshl_b32 s25, s24, 11
  s_add_u32 s57, s57, s25
  s_add_u32 s57, s57, 20480
  s_lshl_b32 s26, s20, 2
  s_and_b32 s27, s23, 2
  s_add_u32 s26, s26, s27
  s_add_u32 s26, s26, s24
  s_mul_i32 s26, s26, 20480
  s_add_u32 s4, s26, 1048576
  s_lshr_b32 s27, s21, 1
  s_mul_i32 s27, s27, 5120
  s_add_u32 s26, s4, s27
  s_and_b32 s5, s21, 1
  s_and_b32 s6, s23, 1
  s_lshl1_add_u32 s5, s5, s6
  s_lshl_b32 s28, s5, 10
  s_add_u32 s28, s28, s26
  s_lshl_b32 s29, s5, 8
  s_add_u32 s29, s29, s26
  s_add_u32 s29, s29, 4096
  s_mul_i32 s30, s5, -768
  s_add_u32 s30, s30, 3072
  s_add_u32 s5, s4, 5120
  s_add_u32 s6, s4, 10240
  s_add_u32 s7, s4, 15360
  s_mov_b32 s36, 8
L_walk:
  s_waitcnt vmcnt(1)
  s_branch L_b2b
.p2align 7
L_tbl:
  s_nop 0
  s_nop 1
  s_nop 2
  s_nop 3
  s_nop 4
  s_nop 5
  s_nop 6
  s_nop 7
  s_nop 8
  s_nop 9
  s_nop 10
  s_nop 11
  s_nop 12
  s_nop 13
  s_nop 14
  s_nop 15
  s_nop 16
  s_nop 17
  s_nop 18
  s_nop 19
  s_nop 20
S_pp:
  v_cmp_lt_u32 vcc, 15, v1
  s_cmp_lt_u32 s58, 3
  s_cbranch_scc1 S_pp2
  s_cmp_eq_u32 s58, 3
  v_mov_b32 v9, v11
  s_cbranch_scc1 S_pp2
  s_and_b32 s25, vcc_lo, 0xff00
  s_cbranch_scc1 S_pp2
S_pp3:
  s_lshl_b32 s11, s3, 15
  s_branch L_pgo
S_pp2:
  s_add_u32 s58, s58, 1
  s_cmp_gt_u32 s58, 262144
  s_cbranch_scc1 S_pp3
  buffer_load_dwordx4 v[148:151], v9, s[40:43], s10 offen sc1
  s_waitcnt vmcnt(0)
  s_branch L_pp
S_n24:
  s_nop 15
  ds_read_b32 v2, v152 offset:0
  s_add_u32 s49, s49, 1
  s_cmp_gt_u32 s49, 1048576
  s_waitcnt lgkmcnt(0)
  v_readfirstlane_b32 s51, v2
  s_cbranch_scc1 L_n24
  s_cmp_ge_u32 s51, 3212836865
  s_cbranch_scc0 S_n24
  s_branch L_n24
S_n25:
  ds_read_b32 v10, v152 offset:32
  s_add_u32 s49, s49, 1
  s_cmp_gt_u32 s49, 1048576
  s_waitcnt lgkmcnt(0)
  v_readfirstlane_b32 s58, v10
  s_cbranch_scc1 L_n25
  s_cmp_eq_u32 s58, 2004318068
  s_cbranch_scc0 S_n25
  s_branch L_n25
S_n26:
  ds_read_b32 v10, v152 offset:36
  s_add_u32 s49, s49, 1
  s_cmp_gt_u32 s49, 1048576
  s_waitcnt lgkmcnt(0)
  v_readfirstlane_b32 s58, v10
  s_cbranch_scc1 L_n26
  s_cmp_eq_u32 s58, 2004318068
  s_cbranch_scc0 S_n26
  s_branch L_n26
S_n27:
  ds_read_b32 v10, v152 offset:40
  s_add_u32 s49, s49, 1
  s_cmp_gt_u32 s49, 1048576
  s_waitcnt lgkmcnt(0)
  v_readfirstlane_b32 s58, v10
  s_cbranch_scc1 L_n27
  s_cmp_eq_u32 s58, 2004318068
  s_cbranch_scc0 S_n27
  s_branch L_n27
S_n1:
  s_nop 7
  ds_read_b64 v[8:9], v1
  s_add_u32 s49, s49, 1
  s_cmp_gt_u32 s49, 1048576
  s_waitcnt lgkmcnt(0)
  v_min_u32 v9, v8, v9
  s_nop 0
  v_readfirstlane_b32 s58, v9
  s_cbranch_scc1 L_n1
  s_cmp_ge_u32 s58, 3212836865
  s_cbranch_scc0 S_n1
  s_branch L_n1
S_n2:
  ds_read_b32 v2, v152 offset:0
  s_add_u32 s49, s49, 1
  s_cmp_gt_u32 s49, 1048576
  s_waitcnt lgkmcnt(0)
  v_readfirstlane_b32 s51, v2
  s_cbranch_scc1 L_n2
  s_cmp_ge_u32 s51, 3212836865
  s_cbranch_scc0 S_n2
  s_branch L_n2
S_n3:
  ds_read_b32 v2, v152 offset:0
  s_add_u32 s49, s49, 1
  s_cmp_gt_u32 s49, 1048576
  s_waitcnt lgkmcnt(0)
  v_readfirstlane_b32 s51, v2
  s_cbranch_scc1 L_n3
  s_cmp_ge_u32 s51, 3212836866
  s_cbranch_scc0 S_n3
  s_branch L_n3
S_n4:
  ds_read_b64 v[8:9], v1
  s_add_u32 s49, s49, 1
  s_cmp_gt_u32 s49, 1048576
  s_waitcnt lgkmcnt(0)
  v_min_u32 v9, v8, v9
  s_nop 0
  v_readfirstlane_b32 s58, v9
  s_cbranch_scc1 L_n4
  s_cmp_ge_u32 s58, 3212836866
  s_cbranch_scc0 S_n4
  s_branch L_n4
S_n5:
  ds_read_b32 v2, v152 offset:4
  s_add_u32 s49, s49, 1
  s_cmp_gt_u32 s49, 1048576
  s_waitcnt lgkmcnt(0)
  v_readfirstlane_b32 s51, v2
  s_cbranch_scc1 L_n5
  s_cmp_ge_u32 s51, 3212836867
  s_cbranch_scc0 S_n5
  s_branch L_n5
S_n6:
  ds_read_b32 v2, v152 offset:4
  s_add_u32 s49, s49, 1
  s_cmp_gt_u32 s49, 1048576
  s_waitcnt lgkmcnt(0)
  v_readfirstlane_b32 s51, v2
  s_cbranch_scc1 L_n6
  s_cmp_ge_u32 s51, 3212836868
  s_cbranch_scc0 S_n6
  s_branch L_n6
S_n7:
  ds_read_b32 v2, v152 offset:4
  s_add_u32 s49, s49, 1
  s_cmp_gt_u32 s49, 1048576
  s_waitcnt lgkmcnt(0)
  v_readfirstlane_b32 s51, v2
  s_cbranch_scc1 L_n7
  s_cmp_ge_u32 s51, 3212836869
  s_cbranch_scc0 S_n7
  s_branch L_n7
S_n8:
  ds_read_b64 v[8:9], v1
  s_add_u32 s49, s49, 1
  s_cmp_gt_u32 s49, 1048576
  s_waitcnt lgkmcnt(0)
  v_min_u32 v9, v8, v9
  s_nop 0
  v_readfirstlane_b32 s58, v9
  s_cbranch_scc1 L_n8
  s_cmp_ge_u32 s58, 3212836867
  s_cbranch_scc0 S_n8
  s_branch L_n8
S_n9:
  ds_read_b32 v2, v152 offset:4
  s_add_u32 s49, s49, 1
  s_cmp_gt_u32 s49, 1048576
  s_waitcnt lgkmcnt(0)
  v_readfirstlane_b32 s51, v2
  s_cbranch_scc1 L_n9
  s_cmp_ge_u32 s51, 3212836870
  s_cbranch_scc0 S_n9
  s_branch L_n9
S_n10:
  ds_read_b32 v2, v152 offset:4
  s_add_u32 s49, s49, 1
  s_cmp_gt_u32 s49, 1048576
  s_waitcnt lgkmcnt(0)
  v_readfirstlane_b32 s51, v2
  s_cbranch_scc1 L_n10
  s_cmp_ge_u32 s51, 3212836871
  s_cbranch_scc0 S_n10
  s_branch L_n10
S_n11:
  ds_read_b32 v2, v152 offset:4
  s_add_u32 s49, s49, 1
  s_cmp_gt_u32 s49, 1048576
  s_waitcnt lgkmcnt(0)
  v_readfirstlane_b32 s51, v2
  s_cbranch_scc1 L_n11
  s_cmp_ge_u32 s51, 3212836872
  s_cbranch_scc0 S_n11
  s_branch L_n11
S_n12:
  ds_read_b32 v2, v152 offset:4
  s_add_u32 s49, s49, 1
  s_cmp_gt_u32 s49, 1048576
  s_waitcnt lgkmcnt(0)
  v_readfirstlane_b32 s51, v2
  s_cbranch_scc1 L_n12
  s_cmp_ge_u32 s51, 3212836873
  s_cbranch_scc0 S_n12
  s_branch L_n12
S_n13:
  ds_read_b32 v2, v152 offset:4
  s_add_u32 s49, s49, 1
  s_cmp_gt_u32 s49, 1048576
  s_waitcnt lgkmcnt(0)
  v_readfirstlane_b32 s51, v2
  s_cbranch_scc1 L_n13
  s_cmp_ge_u32 s51, 3212836874
  s_cbranch_scc0 S_n13
  s_branch L_n13
S_n14:
  ds_read_b32 v2, v152 offset:4
  s_add_u32 s49, s49, 1
  s_cmp_gt_u32 s49, 1048576
  s_waitcnt lgkmcnt(0)
  v_readfirstlane_b32 s51, v2
  s_cbranch_scc1 L_n14
  s_cmp_ge_u32 s51, 3212836875
  s_cbranch_scc0 S_n14
  s_branch L_n14
S_n15:
  ds_read_b32 v2, v152 offset:4
  s_add_u32 s49, s49, 1
  s_cmp_gt_u32 s49, 1048576
  s_waitcnt lgkmcnt(0)
  v_readfirstlane_b32 s51, v2
  s_cbranch_scc1 L_n15
  s_cmp_ge_u32 s51, 3212836876
  s_cbranch_scc0 S_n15
  s_branch L_n15
S_n16:
  ds_read_b32 v2, v152 offset:4
  s_add_u32 s49, s49, 1
  s_cmp_gt_u32 s49, 1048576
  s_waitcnt lgkmcnt(0)
  v_readfirstlane_b32 s51, v2
  s_cbranch_scc1 L_n16
  s_cmp_ge_u32 s51, 3212836877
  s_cbranch_scc0 S_n16
  s_branch L_n16
S_n17:
  ds_read_b32 v2, v152 offset:4
  s_add_u32 s49, s49, 1
  s_cmp_gt_u32 s49, 1048576
  s_waitcnt lgkmcnt(0)
  v_readfirstlane_b32 s51, v2
  s_cbranch_scc1 L_n17
  s_cmp_ge_u32 s51, 3212836878
  s_cbranch_scc0 S_n17
  s_branch L_n17
S_n18:
  ds_read_b32 v2, v152 offset:4
  s_add_u32 s49, s49, 1
  s_cmp_gt_u32 s49, 1048576
  s_waitcnt lgkmcnt(0)
  v_readfirstlane_b32 s51, v2
  s_cbranch_scc1 L_n18
  s_cmp_ge_u32 s51, 3212836879
  s_cbranch_scc0 S_n18
  s_branch L_n18
S_n19:
  ds_read_b32 v2, v152 offset:4
  s_add_u32 s49, s49, 1
  s_cmp_gt_u32 s49, 1048576
  s_waitcnt lgkmcnt(0)
  v_readfirstlane_b32 s51, v2
  s_cbranch_scc1 L_n19
  s_cmp_ge_u32 s51, 3212836880
  s_cbranch_scc0 S_n19
  s_branch L_n19
S_n20:
  ds_read_b32 v2, v152 offset:4
  s_add_u32 s49, s49, 1
  s_cmp_gt_u32 s49, 1048576
  s_waitcnt lgkmcnt(0)
  v_readfirstlane_b32 s51, v2
  s_cbranch_scc1 L_n20
  s_cmp_ge_u32 s51, 3212836881
  s_cbranch_scc0 S_n20
  s_branch L_n20
S_n21:
  ds_read_b32 v2, v152 offset:4
  s_add_u32 s49, s49, 1
  s_cmp_gt_u32 s49, 1048576
  s_waitcnt lgkmcnt(0)
  v_readfirstlane_b32 s51, v2
  s_cbranch_scc1 L_n21
  s_cmp_ge_u32 s51, 3212836882
  s_cbranch_scc0 S_n21
  s_branch L_n21
S_n22:
  ds_read_b32 v2, v152 offset:4
  s_add_u32 s49, s49, 1
  s_cmp_gt_u32 s49, 1048576
  s_waitcnt lgkmcnt(0)
  v_readfirstlane_b32 s51, v2
  s_cbranch_scc1 L_n22
  s_cmp_ge_u32 s51, 3212836883
  s_cbranch_scc0 S_n22
  s_branch L_n22
S_n23:
  ds_read_b32 v2, v152 offset:4
  s_add_u32 s49, s49, 1
  s_cmp_gt_u32 s49, 1048576
  s_waitcnt lgkmcnt(0)
  v_readfirstlane_b32 s51, v2
  s_cbranch_scc1 L_n23
  s_cmp_ge_u32 s51, 3212836884
  s_cbranch_scc0 S_n23
  s_branch L_n23
S_pc:
  s_add_u32 s49, s49, 1
  s_cmp_gt_u32 s49, 262144
  s_cbranch_scc1 A_pc_ok
  s_mov_b32 s27, 262144
  buffer_load_dwordx4 v[148:151], v145, s[40:43], s27 offen sc1
  s_waitcnt vmcnt(0)
  s_branch A_pc
S_p0:
  s_mov_b32 s27, 262144
  buffer_load_dwordx4 v[148:151], v145, s[40:43], s27 offen sc1
  s_branch A_p0
S_p2:
  s_waitcnt vmcnt(0)
  v_xor_b32 v1, s62, v148
  v_xor_b32 v2, s62, v149
  v_xor_b32 v3, s62, v150
  v_xor_b32 v4, s62, v151
  v_or3_b32 v1, v1, v2, v3
  v_or_b32 v1, v1, v4
  v_cmp_lt_u32 vcc, 15, v1
  s_add_u32 s49, s49, 1
  s_cmp_gt_u32 s49, 262144
  s_cbranch_scc1 S_p3
  s_bitcmp1_b32 vcc_lo, 1
  s_cbranch_scc0 S_p3
  buffer_load_dwordx4 v[148:151], v145, s[40:43], s27 offen sc1
  s_branch S_p2
S_p3:
  buffer_load_dwordx4 v6, s[40:43], s51 offen offset:0 sc1 lds
  buffer_load_dwordx4 v6, s[40:43], s51 offen offset:1024 sc1 lds
  s_branch A_p2
S_f2:
  s_lshl_b32 s25, s20, 7
  s_lshl_b32 s26, s21, 2
  s_add_u32 s25, s25, s26
  s_add_u32 s25, s25, 278528
  s_or_b32 s26, s62, s16
  v_mov_b32 v2, s26
  s_mov_b64 exec, 1
  buffer_store_dword v2, off, s[40:43], s25 sc1
  s_mov_b64 exec, -1
  s_branch A_f2
S_f2c:
  s_add_u32 s49, s49, 1
  s_cmp_gt_u32 s49, 262144
  s_cbranch_scc1 A_f2c_ok
  s_mov_b32 s27, 278528
  buffer_load_dword v148, v146, s[40:43], s27 offen sc1
  s_waitcnt vmcnt(0)
  s_branch A_f2c
S_x1:
  s_add_u32 s49, s49, 1
  s_cmp_gt_u32 s49, 4194304
  s_cbranch_scc1 A_x1
  s_setprio 0
  ds_read_b32 v8, v12 offset:0
  ds_read_b128 v[36:39], v242 offset:0
  ds_read_b128 v[40:43], v242 offset:1024
  ds_read_b128 v[44:47], v242 offset:2048
  s_waitcnt lgkmcnt(0)
  v_cmp_ge_u32 vcc, s60, v8
  s_nop 0
  s_cbranch_vccnz S_x1
  s_setprio 1
  s_branch A_x1
O_slow1:
  s_cmp_lg_u64 vcc, 0
  s_cselect_b32 s25, 1, 0
  s_andn2_b32 s25, s25, s60
  s_cbranch_scc1 O_bad1
  s_andn2_b32 s25, s60, s59
  s_cbranch_scc1 O_std1
  buffer_store_dwordx4 v[48:51], v6, s[40:43], s28 offen sc1
  s_mov_b32 exec_hi, 0
  buffer_store_dwordx2 v[52:53], v147, s[40:43], s29 offen sc1
  s_branch O_std1
O_bad1:
  s_mov_b32 s59, 1
  v_mov_b32 v14, 0x101
  s_branch O_std1
O_c01_r:
  s_add_u32 s49, s49, 1
  s_cmp_gt_u32 s49, 262144
  s_cbranch_scc1 O_c01_ok
  buffer_load_dwordx4 v[16:19], v236, s[40:43], s4 offen offset:0 sc1
  buffer_load_dwordx4 v[20:23], v236, s[40:43], s4 offen offset:2048 sc1
  buffer_load_dwordx4 v[24:27], v236, s[40:43], s5 offen offset:0 sc1
  buffer_load_dwordx4 v[28:31], v236, s[40:43], s5 offen offset:2048 sc1
  buffer_load_dwordx2 v[32:33], v237, s[40:43], s4 offen sc1
  buffer_load_dwordx2 v[34:35], v237, s[40:43], s4 offen offset:256 sc1
  buffer_load_dwordx4 v[36:39], v236, s[40:43], s6 offen offset:0 sc1
  buffer_load_dwordx4 v[40:43], v236, s[40:43], s6 offen offset:2048 sc1
  buffer_load_dwordx4 v[44:47], v236, s[40:43], s7 offen offset:0 sc1
  buffer_load_dwordx4 v[48:51], v236, s[40:43], s7 offen offset:2048 sc1
  buffer_load_dwordx2 v[52:53], v237, s[40:43], s6 offen sc1
  buffer_load_dwordx2 v[54:55], v237, s[40:43], s6 offen offset:256 sc1
  s_waitcnt vmcnt(11)
  v_max3_u32 v7, v16, v17, v18
  v_max_u32 v7, v7, v19
  v_cmp_eq_u32 vcc, -1, v7
  s_nop 0
  s_cbranch_vccz O_c01_ok
  ds_read_b32 v10, v13
  s_waitcnt lgkmcnt(0)
  v_readfirstlane_b32 s25, v10
  s_xor_b32 s26, s25, s36
  s_cbranch_scc0 O_c01_r
  s_and_b32 s26, s26, 255
  s_cbranch_scc0 A_fallback
  s_branch O_c01_r
O_c11_r:
  s_add_u32 s49, s49, 1
  s_cmp_gt_u32 s49, 262144
  s_cbranch_scc1 O_c11_ok
  buffer_load_dwordx4 v[20:23], v236, s[40:43], s4 offen offset:2048 sc1
  buffer_load_dwordx4 v[24:27], v236, s[40:43], s5 offen offset:0 sc1
  buffer_load_dwordx4 v[28:31], v236, s[40:43], s5 offen offset:2048 sc1
  buffer_load_dwordx2 v[32:33], v237, s[40:43], s4 offen sc1
  buffer_load_dwordx2 v[34:35], v237, s[40:43], s4 offen offset:256 sc1
  buffer_load_dwordx4 v[36:39], v236, s[40:43], s6 offen offset:0 sc1
  buffer_load_dwordx4 v[40:43], v236, s[40:43], s6 offen offset:2048 sc1
  buffer_load_dwordx4 v[44:47], v236, s[40:43], s7 offen offset:0 sc1
  buffer_load_dwordx4 v[48:51], v236, s[40:43], s7 offen offset:2048 sc1
  buffer_load_dwordx2 v[52:53], v237, s[40:43], s6 offen sc1
  buffer_load_dwordx2 v[54:55], v237, s[40:43], s6 offen offset:256 sc1
  s_waitcnt vmcnt(10)
  v_max3_u32 v7, v20, v21, v22
  v_max_u32 v7, v7, v23
  v_cmp_eq_u32 vcc, -1, v7
  s_nop 0
  s_cbranch_vccz O_c11_ok
  ds_read_b32 v10, v13
  s_waitcnt lgkmcnt(0)
  v_readfirstlane_b32 s25, v10
  s_xor_b32 s26, s25, s36
  s_cbranch_scc0 O_c11_r
  s_and_b32 s26, s26, 255
  s_cbranch_scc0 A_fallback
  s_branch O_c11_r
O_c21_r:
  s_add_u32 s49, s49, 1
  s_cmp_gt_u32 s49, 262144
  s_cbranch_scc1 O_c21_ok
  buffer_load_dwordx4 v[24:27], v236, s[40:43], s5 offen offset:0 sc1
  buffer_load_dwordx4 v[28:31], v236, s[40:43], s5 offen offset:2048 sc1
  buffer_load_dwordx2 v[32:33], v237, s[40:43], s4 offen sc1
  buffer_load_dwordx2 v[34:35], v237, s[40:43], s4 offen offset:256 sc1
  buffer_load_dwordx4 v[36:39], v236, s[40:43], s6 offen offset:0 sc1
  buffer_load_dwordx4 v[40:43], v236, s[40:43], s6 offen offset:2048 sc1
  buffer_load_dwordx4 v[44:47], v236, s[40:43], s7 offen offset:0 sc1
  buffer_load_dwordx4 v[48:51], v236, s[40:43], s7 offen offset:2048 sc1
  buffer_load_dwordx2 v[52:53], v237, s[40:43], s6 offen sc1
  buffer_load_dwordx2 v[54:55], v237, s[40:43], s6 offen offset:256 sc1
  s_waitcnt vmcnt(9)
  v_max3_u32 v7, v24, v25, v26
  v_max_u32 v7, v7, v27
  v_cmp_eq_u32 vcc, -1, v7
  s_nop 0
  s_cbranch_vccz O_c21_ok
  ds_read_b32 v10, v13
  s_waitcnt lgkmcnt(0)
  v_readfirstlane_b32 s25, v10
  s_xor_b32 s26, s25, s36
  s_cbranch_scc0 O_c21_r
  s_and_b32 s26, s26, 255
  s_cbranch_scc0 A_fallback
  s_branch O_c21_r
O_c31_r:
  s_add_u32 s49, s49, 1
  s_cmp_gt_u32 s49, 262144
  s_cbranch_scc1 O_c31_ok
  buffer_load_dwordx4 v[28:31], v236, s[40:43], s5 offen offset:2048 sc1
  buffer_load_dwordx2 v[32:33], v237, s[40:43], s4 offen sc1
  buffer_load_dwordx2 v[34:35], v237, s[40:43], s4 offen offset:256 sc1
  buffer_load_dwordx4 v[36:39], v236, s[40:43], s6 offen offset:0 sc1
  buffer_load_dwordx4 v[40:43], v236, s[40:43], s6 offen offset:2048 sc1
  buffer_load_dwordx4 v[44:47], v236, s[40:43], s7 offen offset:0 sc1
  buffer_load_dwordx4 v[48:51], v236, s[40:43], s7 offen offset:2048 sc1
  buffer_load_dwordx2 v[52:53], v237, s[40:43], s6 offen sc1
  buffer_load_dwordx2 v[54:55], v237, s[40:43], s6 offen offset:256 sc1
  s_waitcnt vmcnt(8)
  v_max3_u32 v7, v28, v29, v30
  v_max_u32 v7, v7, v31
  v_cmp_eq_u32 vcc, -1, v7
  s_nop 0
  s_cbranch_vccz O_c31_ok
  ds_read_b32 v10, v13
  s_waitcnt lgkmcnt(0)
  v_readfirstlane_b32 s25, v10
  s_xor_b32 s26, s25, s36
  s_cbranch_scc0 O_c31_r
  s_and_b32 s26, s26, 255
  s_cbranch_scc0 A_fallback
  s_branch O_c31_r
O_c41_r:
  s_add_u32 s49, s49, 1
  s_cmp_gt_u32 s49, 262144
  s_cbranch_scc1 O_c41_ok
  buffer_load_dwordx2 v[32:33], v237, s[40:43], s4 offen sc1
  buffer_load_dwordx2 v[34:35], v237, s[40:43], s4 offen offset:256 sc1
  buffer_load_dwordx4 v[36:39], v236, s[40:43], s6 offen offset:0 sc1
  buffer_load_dwordx4 v[40:43], v236, s[40:43], s6 offen offset:2048 sc1
  buffer_load_dwordx4 v[44:47], v236, s[40:43], s7 offen offset:0 sc1
  buffer_load_dwordx4 v[48:51], v236, s[40:43], s7 offen offset:2048 sc1
  buffer_load_dwordx2 v[52:53], v237, s[40:43], s6 offen sc1
  buffer_load_dwordx2 v[54:55], v237, s[40:43], s6 offen offset:256 sc1
  s_waitcnt vmcnt(6)
  v_max3_u32 v7, v32, v33, v34
  v_max_u32 v7, v7, v35
  v_cmp_eq_u32 vcc, -1, v7
  s_nop 0
  s_cbranch_vccz O_c41_ok
  ds_read_b32 v10, v13
  s_waitcnt lgkmcnt(0)
  v_readfirstlane_b32 s25, v10
  s_xor_b32 s26, s25, s36
  s_cbranch_scc0 O_c41_r
  s_and_b32 s26, s26, 255
  s_cbranch_scc0 A_fallback
  s_branch O_c41_r
O_c51_r:
  s_add_u32 s49, s49, 1
  s_cmp_gt_u32 s49, 262144
  s_cbranch_scc1 O_c51_ok
  buffer_load_dwordx4 v[36:39], v236, s[40:43], s6 offen offset:0 sc1
  buffer_load_dwordx4 v[40:43], v236, s[40:43], s6 offen offset:2048 sc1
  buffer_load_dwordx4 v[44:47], v236, s[40:43], s7 offen offset:0 sc1
  buffer_load_dwordx4 v[48:51], v236, s[40:43], s7 offen offset:2048 sc1
  buffer_load_dwordx2 v[52:53], v237, s[40:43], s6 offen sc1
  buffer_load_dwordx2 v[54:55], v237, s[40:43], s6 offen offset:256 sc1
  s_waitcnt vmcnt(5)
  v_max3_u32 v7, v36, v37, v38
  v_max_u32 v7, v7, v39
  v_cmp_eq_u32 vcc, -1, v7
  s_nop 0
  s_cbranch_vccz O_c51_ok
  ds_read_b32 v10, v13
  s_waitcnt lgkmcnt(0)
  v_readfirstlane_b32 s25, v10
  s_xor_b32 s26, s25, s36
  s_cbranch_scc0 O_c51_r
  s_and_b32 s26, s26, 255
  s_cbranch_scc0 A_fallback
  s_branch O_c51_r
O_c61_r:
  s_add_u32 s49, s49, 1
  s_cmp_gt_u32 s49, 262144
  s_cbranch_scc1 O_c61_ok
  buffer_load_dwordx4 v[40:43], v236, s[40:43], s6 offen offset:2048 sc1
  buffer_load_dwordx4 v[44:47], v236, s[40:43], s7 offen offset:0 sc1
  buffer_load_dwordx4 v[48:51], v236, s[40:43], s7 offen offset:2048 sc1
  buffer_load_dwordx2 v[52:53], v237, s[40:43], s6 offen sc1
  buffer_load_dwordx2 v[54:55], v237, s[40:43], s6 offen offset:256 sc1
  s_waitcnt vmcnt(4)
  v_max3_u32 v7, v40, v41, v42
  v_max_u32 v7, v7, v43
  v_cmp_eq_u32 vcc, -1, v7
  s_nop 0
  s_cbranch_vccz O_c61_ok
  ds_read_b32 v10, v13
  s_waitcnt lgkmcnt(0)
  v_readfirstlane_b32 s25, v10
  s_xor_b32 s26, s25, s36
  s_cbranch_scc0 O_c61_r
  s_and_b32 s26, s26, 255
  s_cbranch_scc0 A_fallback
  s_branch O_c61_r
O_c71_r:
  s_add_u32 s49, s49, 1
  s_cmp_gt_u32 s49, 262144
  s_cbranch_scc1 O_c71_ok
  buffer_load_dwordx4 v[44:47], v236, s[40:43], s7 offen offset:0 sc1
  buffer_load_dwordx4 v[48:51], v236, s[40:43], s7 offen offset:2048 sc1
  buffer_load_dwordx2 v[52:53], v237, s[40:43], s6 offen sc1
  buffer_load_dwordx2 v[54:55], v237, s[40:43], s6 offen offset:256 sc1
  s_waitcnt vmcnt(3)
  v_max3_u32 v7, v44, v45, v46
  v_max_u32 v7, v7, v47
  v_cmp_eq_u32 vcc, -1, v7
  s_nop 0
  s_cbranch_vccz O_c71_ok
  ds_read_b32 v10, v13
  s_waitcnt lgkmcnt(0)
  v_readfirstlane_b32 s25, v10
  s_xor_b32 s26, s25, s36
  s_cbranch_scc0 O_c71_r
  s_and_b32 s26, s26, 255
  s_cbranch_scc0 A_fallback
  s_branch O_c71_r
O_c81_r:
  s_add_u32 s49, s49, 1
  s_cmp_gt_u32 s49, 262144
  s_cbranch_scc1 O_c81_ok
  buffer_load_dwordx4 v[48:51], v236, s[40:43], s7 offen offset:2048 sc1
  buffer_load_dwordx2 v[52:53], v237, s[40:43], s6 offen sc1
  buffer_load_dwordx2 v[54:55], v237, s[40:43], s6 offen offset:256 sc1
  s_waitcnt vmcnt(2)
  v_max3_u32 v7, v48, v49, v50
  v_max_u32 v7, v7, v51
  v_cmp_eq_u32 vcc, -1, v7
  s_nop 0
  s_cbranch_vccz O_c81_ok
  ds_read_b32 v10, v13
  s_waitcnt lgkmcnt(0)
  v_readfirstlane_b32 s25, v10
  s_xor_b32 s26, s25, s36
  s_cbranch_scc0 O_c81_r
  s_and_b32 s26, s26, 255
  s_cbranch_scc0 A_fallback
  s_branch O_c81_r
O_c91_r:
  s_add_u32 s49, s49, 1
  s_cmp_gt_u32 s49, 262144
  s_cbranch_scc1 O_c91_ok
  buffer_load_dwordx2 v[52:53], v237, s[40:43], s6 offen sc1
  buffer_load_dwordx2 v[54:55], v237, s[40:43], s6 offen offset:256 sc1
  s_waitcnt vmcnt(0)
  v_max3_u32 v7, v52, v53, v54
  v_max_u32 v7, v7, v55
  v_cmp_eq_u32 vcc, -1, v7
  s_nop 0
  s_cbranch_vccz O_c91_ok
  ds_read_b32 v10, v13
  s_waitcnt lgkmcnt(0)
  v_readfirstlane_b32 s25, v10
  s_xor_b32 s26, s25, s36
  s_cbranch_scc0 O_c91_r
  s_and_b32 s26, s26, 255
  s_cbranch_scc0 A_fallback
  s_branch O_c91_r
O_pr:
  s_add_u32 s49, s49, 1
  s_cmp_gt_u32 s49, 4194304
  s_cbranch_scc1 O_pok
  ds_read_b32 v10, v13
  s_waitcnt lgkmcnt(0)
  v_readfirstlane_b32 s25, v10
  s_xor_b32 s26, s25, s36
  s_cbranch_scc0 O_pr2
  s_and_b32 s26, s26, 255
  s_cbranch_scc0 A_fallback
O_pr2:
  ds_read_b32 v8, v12
  ds_read_b128 v[56:59], v238 offset:0
  ds_read_b128 v[60:63], v238 offset:1024
  ds_read_b128 v[64:67], v238 offset:2048
  ds_read_b128 v[68:71], v238 offset:3072
  ds_read_b128 v[72:75], v238 offset:4096
  s_branch O_pc
S_x0:
  s_add_u32 s49, s49, 1
  s_cmp_gt_u32 s49, 4194304
  s_cbranch_scc1 A_x0
  s_setprio 0
  ds_read_b32 v8, v12 offset:16
  ds_read_b128 v[36:39], v242 offset:0
  ds_read_b128 v[40:43], v242 offset:1024
  ds_read_b128 v[44:47], v242 offset:2048
  s_waitcnt lgkmcnt(0)
  v_cmp_ge_u32 vcc, s60, v8
  s_nop 0
  s_cbranch_vccnz S_x0
  s_setprio 2
  s_branch A_x0
O_slow0:
  s_cmp_lg_u64 vcc, 0
  s_cselect_b32 s25, 1, 0
  s_andn2_b32 s25, s25, s60
  s_cbranch_scc1 O_bad0
  s_andn2_b32 s25, s60, s59
  s_cbranch_scc1 O_std0
  buffer_store_dwordx4 v[48:51], v6, s[40:43], s28 offen sc1
  s_mov_b32 exec_hi, 0
  buffer_store_dwordx2 v[52:53], v147, s[40:43], s29 offen sc1
  s_branch O_std0
O_bad0:
  s_mov_b32 s59, 1
  v_mov_b32 v14, 0x101
  s_branch O_std0
O_c00_r:
  s_add_u32 s49, s49, 1
  s_cmp_gt_u32 s49, 262144
  s_cbranch_scc1 O_c00_ok
  buffer_load_dwordx4 v[16:19], v236, s[40:43], s4 offen offset:0 sc1
  buffer_load_dwordx4 v[20:23], v236, s[40:43], s4 offen offset:2048 sc1
  buffer_load_dwordx4 v[24:27], v236, s[40:43], s5 offen offset:0 sc1
  buffer_load_dwordx4 v[28:31], v236, s[40:43], s5 offen offset:2048 sc1
  buffer_load_dwordx2 v[32:33], v237, s[40:43], s4 offen sc1
  buffer_load_dwordx2 v[34:35], v237, s[40:43], s4 offen offset:256 sc1
  buffer_load_dwordx4 v[36:39], v236, s[40:43], s6 offen offset:0 sc1
  buffer_load_dwordx4 v[40:43], v236, s[40:43], s6 offen offset:2048 sc1
  buffer_load_dwordx4 v[44:47], v236, s[40:43], s7 offen offset:0 sc1
  buffer_load_dwordx4 v[48:51], v236, s[40:43], s7 offen offset:2048 sc1
  buffer_load_dwordx2 v[52:53], v237, s[40:43], s6 offen sc1
  buffer_load_dwordx2 v[54:55], v237, s[40:43], s6 offen offset:256 sc1
  s_waitcnt vmcnt(11)
  v_max3_u32 v7, v16, v17, v18
  v_max_u32 v7, v7, v19
  v_cmp_eq_u32 vcc, -1, v7
  s_nop 0
  s_cbranch_vccz O_c00_ok
  ds_read_b32 v10, v13
  s_waitcnt lgkmcnt(0)
  v_readfirstlane_b32 s25, v10
  s_xor_b32 s26, s25, s36
  s_cbranch_scc0 O_c00_r
  s_and_b32 s26, s26, 255
  s_cbranch_scc0 A_fallback
  s_branch O_c00_r
O_c10_r:
  s_add_u32 s49, s49, 1
  s_cmp_gt_u32 s49, 262144
  s_cbranch_scc1 O_c10_ok
  buffer_load_dwordx4 v[20:23], v236, s[40:43], s4 offen offset:2048 sc1
  buffer_load_dwordx4 v[24:27], v236, s[40:43], s5 offen offset:0 sc1
  buffer_load_dwordx4 v[28:31], v236, s[40:43], s5 offen offset:2048 sc1
  buffer_load_dwordx2 v[32:33], v237, s[40:43], s4 offen sc1
  buffer_load_dwordx2 v[34:35], v237, s[40:43], s4 offen offset:256 sc1
  buffer_load_dwordx4 v[36:39], v236, s[40:43], s6 offen offset:0 sc1
  buffer_load_dwordx4 v[40:43], v236, s[40:43], s6 offen offset:2048 sc1
  buffer_load_dwordx4 v[44:47], v236, s[40:43], s7 offen offset:0 sc1
  buffer_load_dwordx4 v[48:51], v236, s[40:43], s7 offen offset:2048 sc1
  buffer_load_dwordx2 v[52:53], v237, s[40:43], s6 offen sc1
  buffer_load_dwordx2 v[54:55], v237, s[40:43], s6 offen offset:256 sc1
  s_waitcnt vmcnt(10)
  v_max3_u32 v7, v20, v21, v22
  v_max_u32 v7, v7, v23
  v_cmp_eq_u32 vcc, -1, v7
  s_nop 0
  s_cbranch_vccz O_c10_ok
  ds_read_b32 v10, v13
  s_waitcnt lgkmcnt(0)
  v_readfirstlane_b32 s25, v10
  s_xor_b32 s26, s25, s36
  s_cbranch_scc0 O_c10_r
  s_and_b32 s26, s26, 255
  s_cbranch_scc0 A_fallback
  s_branch O_c10_r
O_c20_r:
  s_add_u32 s49, s49, 1
  s_cmp_gt_u32 s49, 262144
  s_cbranch_scc1 O_c20_ok
  buffer_load_dwordx4 v[24:27], v236, s[40:43], s5 offen offset:0 sc1
  buffer_load_dwordx4 v[28:31], v236, s[40:43], s5 offen offset:2048 sc1
  buffer_load_dwordx2 v[32:33], v237, s[40:43], s4 offen sc1
  buffer_load_dwordx2 v[34:35], v237, s[40:43], s4 offen offset:256 sc1
  buffer_load_dwordx4 v[36:39], v236, s[40:43], s6 offen offset:0 sc1
  buffer_load_dwordx4 v[40:43], v236, s[40:43], s6 offen offset:2048 sc1
  buffer_load_dwordx4 v[44:47], v236, s[40:43], s7 offen offset:0 sc1
  buffer_load_dwordx4 v[48:51], v236, s[40:43], s7 offen offset:2048 sc1
  buffer_load_dwordx2 v[52:53], v237, s[40:43], s6 offen sc1
  buffer_load_dwordx2 v[54:55], v237, s[40:43], s6 offen offset:256 sc1
  s_waitcnt vmcnt(9)
  v_max3_u32 v7, v24, v25, v26
  v_max_u32 v7, v7, v27
  v_cmp_eq_u32 vcc, -1, v7
  s_nop 0
  s_cbranch_vccz O_c20_ok
  ds_read_b32 v10, v13
  s_waitcnt lgkmcnt(0)
  v_readfirstlane_b32 s25, v10
  s_xor_b32 s26, s25, s36
  s_cbranch_scc0 O_c20_r
  s_and_b32 s26, s26, 255
  s_cbranch_scc0 A_fallback
  s_branch O_c20_r
O_c30_r:
  s_add_u32 s49, s49, 1
  s_cmp_gt_u32 s49, 262144
  s_cbranch_scc1 O_c30_ok
  buffer_load_dwordx4 v[28:31], v236, s[40:43], s5 offen offset:2048 sc1
  buffer_load_dwordx2 v[32:33], v237, s[40:43], s4 offen sc1
  buffer_load_dwordx2 v[34:35], v237, s[40:43], s4 offen offset:256 sc1
  buffer_load_dwordx4 v[36:39], v236, s[40:43], s6 offen offset:0 sc1
  buffer_load_dwordx4 v[40:43], v236, s[40:43], s6 offen offset:2048 sc1
  buffer_load_dwordx4 v[44:47], v236, s[40:43], s7 offen offset:0 sc1
  buffer_load_dwordx4 v[48:51], v236, s[40:43], s7 offen offset:2048 sc1
  buffer_load_dwordx2 v[52:53], v237, s[40:43], s6 offen sc1
  buffer_load_dwordx2 v[54:55], v237, s[40:43], s6 offen offset:256 sc1
  s_waitcnt vmcnt(8)
  v_max3_u32 v7, v28, v29, v30
  v_max_u32 v7, v7, v31
  v_cmp_eq_u32 vcc, -1, v7
  s_nop 0
  s_cbranch_vccz O_c30_ok
  ds_read_b32 v10, v13
  s_waitcnt lgkmcnt(0)
  v_readfirstlane_b32 s25, v10
  s_xor_b32 s26, s25, s36
  s_cbranch_scc0 O_c30_r
  s_and_b32 s26, s26, 255
  s_cbranch_scc0 A_fallback
  s_branch O_c30_r
O_c40_r:
  s_add_u32 s49, s49, 1
  s_cmp_gt_u32 s49, 262144
  s_cbranch_scc1 O_c40_ok
  buffer_load_dwordx2 v[32:33], v237, s[40:43], s4 offen sc1
  buffer_load_dwordx2 v[34:35], v237, s[40:43], s4 offen offset:256 sc1
  buffer_load_dwordx4 v[36:39], v236, s[40:43], s6 offen offset:0 sc1
  buffer_load_dwordx4 v[40:43], v236, s[40:43], s6 offen offset:2048 sc1
  buffer_load_dwordx4 v[44:47], v236, s[40:43], s7 offen offset:0 sc1
  buffer_load_dwordx4 v[48:51], v236, s[40:43], s7 offen offset:2048 sc1
  buffer_load_dwordx2 v[52:53], v237, s[40:43], s6 offen sc1
  buffer_load_dwordx2 v[54:55], v237, s[40:43], s6 offen offset:256 sc1
  s_waitcnt vmcnt(6)
  v_max3_u32 v7, v32, v33, v34
  v_max_u32 v7, v7, v35
  v_cmp_eq_u32 vcc, -1, v7
  s_nop 0
  s_cbranch_vccz O_c40_ok
  ds_read_b32 v10, v13
  s_waitcnt lgkmcnt(0)
  v_readfirstlane_b32 s25, v10
  s_xor_b32 s26, s25, s36
  s_cbranch_scc0 O_c40_r
  s_and_b32 s26, s26, 255
  s_cbranch_scc0 A_fallback
  s_branch O_c40_r
O_c50_r:
  s_add_u32 s49, s49, 1
  s_cmp_gt_u32 s49, 262144
  s_cbranch_scc1 O_c50_ok
  buffer_load_dwordx4 v[36:39], v236, s[40:43], s6 offen offset:0 sc1
  buffer_load_dwordx4 v[40:43], v236, s[40:43], s6 offen offset:2048 sc1
  buffer_load_dwordx4 v[44:47], v236, s[40:43], s7 offen offset:0 sc1
  buffer_load_dwordx4 v[48:51], v236, s[40:43], s7 offen offset:2048 sc1
  buffer_load_dwordx2 v[52:53], v237, s[40:43], s6 offen sc1
  buffer_load_dwordx2 v[54:55], v237, s[40:43], s6 offen offset:256 sc1
  s_waitcnt vmcnt(5)
  v_max3_u32 v7, v36, v37, v38
  v_max_u32 v7, v7, v39
  v_cmp_eq_u32 vcc, -1, v7
  s_nop 0
  s_cbranch_vccz O_c50_ok
  ds_read_b32 v10, v13
  s_waitcnt lgkmcnt(0)
  v_readfirstlane_b32 s25, v10
  s_xor_b32 s26, s25, s36
  s_cbranch_scc0 O_c50_r
  s_and_b32 s26, s26, 255
  s_cbranch_scc0 A_fallback
  s_branch O_c50_r
O_c60_r:
  s_add_u32 s49, s49, 1
  s_cmp_gt_u32 s49, 262144
  s_cbranch_scc1 O_c60_ok
  buffer_load_dwordx4 v[40:43], v236, s[40:43], s6 offen offset:2048 sc1
  buffer_load_dwordx4 v[44:47], v236, s[40:43], s7 offen offset:0 sc1
  buffer_load_dwordx4 v[48:51], v236, s[40:43], s7 offen offset:2048 sc1
  buffer_load_dwordx2 v[52:53], v237, s[40:43], s6 offen sc1
  buffer_load_dwordx2 v[54:55], v237, s[40:43], s6 offen offset:256 sc1
  s_waitcnt vmcnt(4)
  v_max3_u32 v7, v40, v41, v42
  v_max_u32 v7, v7, v43
  v_cmp_eq_u32 vcc, -1, v7
  s_nop 0
  s_cbranch_vccz O_c60_ok
  ds_read_b32 v10, v13
  s_waitcnt lgkmcnt(0)
  v_readfirstlane_b32 s25, v10
  s_xor_b32 s26, s25, s36
  s_cbranch_scc0 O_c60_r
  s_and_b32 s26, s26, 255
  s_cbranch_scc0 A_fallback
  s_branch O_c60_r
O_c70_r:
  s_add_u32 s49, s49, 1
  s_cmp_gt_u32 s49, 262144
  s_cbranch_scc1 O_c70_ok
  buffer_load_dwordx4 v[44:47], v236, s[40:43], s7 offen offset:0 sc1
  buffer_load_dwordx4 v[48:51], v236, s[40:43], s7 offen offset:2048 sc1
  buffer_load_dwordx2 v[52:53], v237, s[40:43], s6 offen sc1
  buffer_load_dwordx2 v[54:55], v237, s[40:43], s6 offen offset:256 sc1
  s_waitcnt vmcnt(3)
  v_max3_u32 v7, v44, v45, v46
  v_max_u32 v7, v7, v47
  v_cmp_eq_u32 vcc, -1, v7
  s_nop 0
  s_cbranch_vccz O_c70_ok
  ds_read_b32 v10, v13
  s_waitcnt lgkmcnt(0)
  v_readfirstlane_b32 s25, v10
  s_xor_b32 s26, s25, s36
  s_cbranch_scc0 O_c70_r
  s_and_b32 s26, s26, 255
  s_cbranch_scc0 A_fallback
  s_branch O_c70_r
O_c80_r:
  s_add_u32 s49, s49, 1
  s_cmp_gt_u32 s49, 262144
  s_cbranch_scc1 O_c80_ok
  buffer_load_dwordx4 v[48:51], v236, s[40:43], s7 offen offset:2048 sc1
  buffer_load_dwordx2 v[52:53], v237, s[40:43], s6 offen sc1
  buffer_load_dwordx2 v[54:55], v237, s[40:43], s6 offen offset:256 sc1
  s_waitcnt vmcnt(2)
  v_max3_u32 v7, v48, v49, v50
  v_max_u32 v7, v7, v51
  v_cmp_eq_u32 vcc, -1, v7
  s_nop 0
  s_cbranch_vccz O_c80_ok
  ds_read_b32 v10, v13
  s_waitcnt lgkmcnt(0)
  v_readfirstlane_b32 s25, v10
  s_xor_b32 s26, s25, s36
  s_cbranch_scc0 O_c80_r
  s_and_b32 s26, s26, 255
  s_cbranch_scc0 A_fallback
  s_branch O_c80_r
O_c90_r:
  s_add_u32 s49, s49, 1
  s_cmp_gt_u32 s49, 262144
  s_cbranch_scc1 O_c90_ok
  buffer_load_dwordx2 v[52:53], v237, s[40:43], s6 offen sc1
  buffer_load_dwordx2 v[54:55], v237, s[40:43], s6 offen offset:256 sc1
  s_waitcnt vmcnt(0)
  v_max3_u32 v7, v52, v53, v54
  v_max_u32 v7, v7, v55
  v_cmp_eq_u32 vcc, -1, v7
  s_nop 0
  s_cbranch_vccz O_c90_ok
  ds_read_b32 v10, v13
  s_waitcnt lgkmcnt(0)
  v_readfirstlane_b32 s25, v10
  s_xor_b32 s26, s25, s36
  s_cbranch_scc0 O_c90_r
  s_and_b32 s26, s26, 255
  s_cbranch_scc0 A_fallback
  s_branch O_c90_r
O_kr:
  s_add_u32 s49, s49, 1
  s_cmp_gt_u32 s49, 4194304
  s_cbranch_scc1 O_kok
  ds_read_b32 v10, v13
  s_waitcnt lgkmcnt(0)
  v_readfirstlane_b32 s25, v10
  s_xor_b32 s26, s25, s36
  s_cbranch_scc0 O_kok
  s_and_b32 s26, s26, 255
  s_cbranch_scc0 A_fallback
  s_branch O_kr
L_codeend:
A_fallback:
  s_add_u32 s36, s25, 16
  s_mov_b32 s60, 1
  s_nop 15
  s_waitcnt vmcnt(0) lgkmcnt(0)
  v_lshlrev_b32 v144, 7, v0
  v_lshrrev_b32 v1, 3, v0
  v_and_b32 v2, 7, v0
  v_and_b32 v3, 6, v1
  v_xor_b32 v2, v2, v3
  v_mul_u32_u24 v153, 1280, v1
  v_lshl_add_u32 v153, v2, 4, v153
  s_lshl_b32 s26, s20, 2
  s_add_u32 s26, s26, s23
  s_mul_i32 s52, s26, 20480
  s_mov_b32 s57, s52
  s_mul_i32 s56, s48, 8192
  s_add_u32 s56, s56, 32768
  s_cmp_eq_u32 s48, 0
  s_cselect_b32 s56, 128512, s56
  s_mov_b32 s30, 2621440
  s_mov_b32 s31, 0x20000
  s_mov_b32 s34, 819200
  s_mov_b32 s35, 0x20000
  s_mov_b32 s42, 4194304
  s_mov_b32 s43, 0x20000
  s_mov_b32 s46, 2621440
  s_mov_b32 s47, 0x20000
  s_mov_b32 s49, 0
  v_lshlrev_b32 v6, 4, v0
  v_and_b32 v13, 15, v0
  v_lshrrev_b32 v14, 4, v0
  v_lshrrev_b32 v1, 3, v13
  v_lshlrev_b32 v1, 10, v1
  v_and_b32 v2, 7, v13
  v_lshl_add_u32 v1, v2, 7, v1
  v_and_b32 v2, 6, v13
  v_xor_b32 v2, v2, v14
  v_lshl_add_u32 v1, v2, 4, v1
  v_add_u32 v154, s56, v1
  v_xor_b32 v155, 64, v154
  s_mul_i32 s50, s22, 3072
  v_mov_b32 v5, 0xdddddddd
  s_mul_i32 s25, s21, 160
  s_movk_i32 s26, 1280
  s_movk_i32 s27, 176
  s_mul_i32 s53, s23, 3072
  s_add_u32 s53, s53, 102400
  s_lshl_b32 s54, s24, 7
  v_add_u32 v1, 0, v0
  v_mul_u32_u24 v2, 6554, v1
  v_lshrrev_b32 v2, 16, v2
  v_mul_u32_u24 v3, 10, v2
  v_sub_u32 v1, v1, v3
  v_lshl_add_u32 v3, v1, 4, s53
  v_mad_u32_u24 v244, v2, s27, v3
  v_lshl_add_u32 v1, v1, 4, s25
  v_mad_u32_u24 v3, v2, s26, v1
  v_add_u32 v247, s52, v3
  v_lshrrev_b32 v3, 1, v2
  v_and_b32 v3, 4, v3
  v_xor_b32 v2, v2, v3
  v_mad_u32_u24 v16, v2, s26, v1
  v_and_b32 v3, 3, v2
  v_lshrrev_b32 v4, 4, v2
  v_mad_u32_u24 v3, v4, 20, v3
  v_bfe_u32 v4, v2, 3, 1
  v_lshl_add_u32 v3, v4, 2, v3
  v_bfe_u32 v4, v2, 2, 1
  v_lshl_add_u32 v3, v4, 3, v3
  v_mad_u32_u24 v136, v3, s26, v1
  v_add_u32 v1, 64, v0
  v_mul_u32_u24 v2, 6554, v1
  v_lshrrev_b32 v2, 16, v2
  v_mul_u32_u24 v3, 10, v2
  v_sub_u32 v1, v1, v3
  v_lshl_add_u32 v3, v1, 4, s53
  v_mad_u32_u24 v245, v2, s27, v3
  v_lshl_add_u32 v1, v1, 4, s25
  v_mad_u32_u24 v3, v2, s26, v1
  v_add_u32 v248, s52, v3
  v_lshrrev_b32 v3, 1, v2
  v_and_b32 v3, 4, v3
  v_xor_b32 v2, v2, v3
  v_subrev_u32 v1, 1024, v1
  v_mad_u32_u24 v17, v2, s26, v1
  v_and_b32 v3, 3, v2
  v_lshrrev_b32 v4, 4, v2
  v_mad_u32_u24 v3, v4, 20, v3
  v_bfe_u32 v4, v2, 3, 1
  v_lshl_add_u32 v3, v4, 2, v3
  v_bfe_u32 v4, v2, 2, 1
  v_lshl_add_u32 v3, v4, 3, v3
  v_mad_u32_u24 v137, v3, s26, v1
  v_add_u32 v1, 128, v0
  v_mul_u32_u24 v2, 6554, v1
  v_lshrrev_b32 v2, 16, v2
  v_mul_u32_u24 v3, 10, v2
  v_sub_u32 v1, v1, v3
  v_lshl_add_u32 v3, v1, 4, s53
  v_mad_u32_u24 v246, v2, s27, v3
  v_lshl_add_u32 v1, v1, 4, s25
  v_mad_u32_u24 v3, v2, s26, v1
  v_add_u32 v249, s52, v3
  v_lshrrev_b32 v3, 1, v2
  v_and_b32 v3, 4, v3
  v_xor_b32 v2, v2, v3
  v_subrev_u32 v1, 2048, v1
  v_mad_u32_u24 v18, v2, s26, v1
  v_and_b32 v3, 3, v2
  v_lshrrev_b32 v4, 4, v2
  v_mad_u32_u24 v3, v4, 20, v3
  v_bfe_u32 v4, v2, 3, 1
  v_lshl_add_u32 v3, v4, 2, v3
  v_bfe_u32 v4, v2, 2, 1
  v_lshl_add_u32 v3, v4, 3, v3
  v_mad_u32_u24 v138, v3, s26, v1
  v_add_u32 v1, 192, v0
  v_mul_u32_u24 v2, 6554, v1
  v_lshrrev_b32 v2, 16, v2
  v_mul_u32_u24 v3, 10, v2
  v_sub_u32 v1, v1, v3
  v_lshl_add_u32 v1, v1, 4, s25
  v_lshrrev_b32 v3, 1, v2
  v_and_b32 v3, 4, v3
  v_xor_b32 v2, v2, v3
  v_subrev_u32 v1, 3072, v1
  v_mad_u32_u24 v19, v2, s26, v1
  v_and_b32 v3, 3, v2
  v_lshrrev_b32 v4, 4, v2
  v_mad_u32_u24 v3, v4, 20, v3
  v_bfe_u32 v4, v2, 3, 1
  v_lshl_add_u32 v3, v4, 2, v3
  v_bfe_u32 v4, v2, 2, 1
  v_lshl_add_u32 v3, v4, 3, v3
  v_mad_u32_u24 v139, v3, s26, v1
  v_add_u32 v1, 256, v0
  v_mul_u32_u24 v2, 6554, v1
  v_lshrrev_b32 v2, 16, v2
  v_mul_u32_u24 v3, 10, v2
  v_sub_u32 v1, v1, v3
  v_lshl_add_u32 v1, v1, 4, s25
  v_lshrrev_b32 v3, 1, v2
  v_and_b32 v3, 4, v3
  v_xor_b32 v2, v2, v3
  v_mad_u32_u24 v20, v2, s26, v1
  v_and_b32 v3, 3, v2
  v_lshrrev_b32 v4, 4, v2
  v_mad_u32_u24 v3, v4, 20, v3
  v_bfe_u32 v4, v2, 3, 1
  v_lshl_add_u32 v3, v4, 2, v3
  v_bfe_u32 v4, v2, 2, 1
  v_lshl_add_u32 v3, v4, 3, v3
  v_mad_u32_u24 v140, v3, s26, v1
  v_add_u32 v1, s54, v0
  v_mul_u32_u24 v2, 6554, v1
  v_lshrrev_b32 v2, 16, v2
  v_mul_u32_u24 v3, 10, v2
  v_sub_u32 v1, v1, v3
  s_add_u32 s54, s54, 64
  v_lshl_add_u32 v1, v1, 4, s25
  v_lshrrev_b32 v3, 1, v2
  v_and_b32 v3, 4, v3
  v_xor_b32 v2, v2, v3
  v_and_b32 v3, 3, v2
  v_lshrrev_b32 v4, 2, v2
  v_mad_u32_u24 v4, v4, 20, v3
  v_lshrrev_b32 v3, 3, v2
  v_mad_u32_u24 v4, v3, 40, v4
  v_mad_u32_u24 v4, v4, s26, v1
  v_add_u32 v141, 20480, v4
  v_add_u32 v1, s54, v0
  v_mul_u32_u24 v2, 6554, v1
  v_lshrrev_b32 v2, 16, v2
  v_mul_u32_u24 v3, 10, v2
  v_sub_u32 v1, v1, v3
  s_add_u32 s54, s54, 64
  v_lshl_add_u32 v1, v1, 4, s25
  v_lshrrev_b32 v3, 1, v2
  v_and_b32 v3, 4, v3
  v_xor_b32 v2, v2, v3
  v_and_b32 v3, 3, v2
  v_lshrrev_b32 v4, 2, v2
  v_mad_u32_u24 v4, v4, 20, v3
  v_lshrrev_b32 v3, 3, v2
  v_mad_u32_u24 v4, v3, 40, v4
  v_mad_u32_u24 v4, v4, s26, v1
  v_add_u32 v142, 19456, v4
  v_add_u32 v1, s54, v0
  v_mul_u32_u24 v2, 6554, v1
  v_lshrrev_b32 v2, 16, v2
  v_mul_u32_u24 v3, 10, v2
  v_sub_u32 v1, v1, v3
  s_add_u32 s54, s54, 64
  v_lshl_add_u32 v1, v1, 4, s25
  v_lshrrev_b32 v3, 1, v2
  v_and_b32 v3, 4, v3
  v_xor_b32 v2, v2, v3
  v_and_b32 v3, 3, v2
  v_lshrrev_b32 v4, 2, v2
  v_mad_u32_u24 v4, v4, 20, v3
  v_lshrrev_b32 v3, 3, v2
  v_mad_u32_u24 v4, v3, 40, v4
  v_mad_u32_u24 v4, v4, s26, v1
  v_add_u32 v143, 18432, v4
  v_mul_u32_u24 v1, 40, v14
  v_mad_u32_u24 v1, v13, s27, v1
  v_add_u32 v243, s53, v1
  s_mul_i32 s25, s23, 5120
  s_add_u32 s25, s25, 128512
  v_add_u32 v238, s25, v6
  v_bfe_u32 v1, v0, 2, 2
  v_and_b32 v2, 3, v0
  v_lshl_add_u32 v3, v14, 3, v1
  v_and_b32 v4, 1, v14
  v_lshl_add_u32 v4, v4, 2, v3
  v_xor_b32 v7, 4, v4
  v_mul_u32_u24 v8, 40, v2
  s_mul_i32 s26, s24, 51200
  v_add_u32 v8, s26, v8
  s_movk_i32 s27, 160
  v_mad_u32_u24 v239, v4, s27, v8
  v_mad_u32_u24 v240, v7, s27, v8
  v_mov_b32 v152, 163328
  v_xor_b32 v1, s3, v0
  v_and_b32 v1, 7, v1
  v_lshl_add_u32 v1, v1, 3, s22
  v_lshlrev_b32 v145, 7, v1
  v_and_b32 v1, 7, v0
  s_lshl_b32 s26, s20, 7
  v_lshl_add_u32 v146, v1, 2, s26
  v_lshlrev_b32 v147, 3, v0
  s_mul_i32 s25, s24, 12288
  s_add_u32 s25, s25, 102400
  v_add_u32 v232, s25, v6
  s_add_u32 s26, s25, 1024
  v_add_u32 v233, s26, v147
  v_and_b32 v7, 31, v0
  v_lshrrev_b32 v8, 5, v0
  v_mul_u32_u24 v3, 24, v8
  v_min_u32 v10, 23, v7
  v_add_u32 v3, v3, v10
  s_add_u32 s26, s25, 1536
  v_lshl_add_u32 v234, v3, 4, s26
  s_and_b32 s25, s23, 1
  s_mul_i32 s25, s25, 2560
  s_lshr_b32 s26, s23, 1
  s_mul_i32 s26, s26, 1280
  s_add_u32 s25, s25, s26
  s_add_u32 s25, s25, 153088
  s_mul_i32 s26, s24, 5120
  s_sub_u32 s27, 5120, s26
  s_add_u32 s26, s25, s26
  s_add_u32 s27, s25, s27
  v_add_u32 v250, s27, v6
  v_add_u32 v251, s26, v6
  v_lshl_add_u32 v252, v7, 3, s27
  v_lshl_add_u32 v253, v7, 3, s26
  s_lshr_b32 s25, s23, 1
  s_mul_i32 s25, s25, 1280
  s_add_u32 s25, s25, 153088
  s_and_b32 s26, s23, 1
  s_lshl_b32 s26, s26, 4
  v_add_u32 v1, s26, v13
  v_mul_u32_u24 v2, 2560, v14
  v_add_u32 v2, s25, v2
  v_lshl_add_u32 v254, v1, 4, v2
  v_lshl_add_u32 v255, v1, 3, v2
  v_lshrrev_b32 v7, 1, v14
  v_and_b32 v8, 1, v14
  v_lshl_add_u32 v9, v8, 5, v1
  v_lshlrev_b32 v9, 4, v9
  v_lshl_add_u32 v236, v7, 10, v9
  v_mul_u32_u24 v3, 5120, v7
  v_lshl_add_u32 v3, v8, 9, v3
  v_lshl_add_u32 v3, v1, 3, v3
  v_add_u32 v237, 4096, v3
  s_add_u32 s25, s50, 102400
  v_add_u32 v241, s25, v6
  s_xor_b32 s25, s22, 4
  s_mul_i32 s25, s25, 3072
  s_add_u32 s25, s25, 102400
  v_add_u32 v242, s25, v6
  v_mov_b64 v[196:197], 0
  v_mov_b64 v[198:199], 0
  v_mov_b64 v[200:201], 0
  v_mov_b64 v[202:203], 0
  v_mov_b64 v[204:205], 0
  v_mov_b64 v[206:207], 0
  v_mov_b64 v[208:209], 0
  v_mov_b64 v[210:211], 0
  v_mov_b64 v[212:213], 0
  v_mov_b64 v[214:215], 0
  v_mov_b64 v[216:217], 0
  v_mov_b64 v[218:219], 0
  v_mov_b64 v[220:221], 0
  v_mov_b64 v[222:223], 0
  v_mov_b64 v[224:225], 0
  v_mov_b64 v[226:227], 0
  v_mov_b64 v[228:229], 0
  v_mov_b64 v[230:231], 0
  s_and_b32 s56, s23, 1
  s_lshl_b32 s56, s56, 3
  s_lshr_b32 s57, s23, 1
  s_add_u32 s56, s56, s57
  s_mul_i32 s56, s56, 51200
  s_mul_i32 s57, s23, 25600
  s_mul_i32 s25, s24, 102400
  s_add_u32 s52, s56, s25
  s_add_u32 s54, s52, 204800
  s_mul_i32 s25, s24, 5120
  s_add_u32 s53, s57, s25
  s_add_u32 s55, s53, 10240
  s_lshl_b32 s25, s24, 11
  s_add_u32 s57, s57, s25
  s_add_u32 s57, s57, 20480
  s_lshl_b32 s26, s20, 2
  s_and_b32 s27, s23, 2
  s_add_u32 s26, s26, s27
  s_add_u32 s26, s26, s24
  s_mul_i32 s26, s26, 20480
  s_add_u32 s4, s26, 1048576
  s_lshr_b32 s27, s21, 1
  s_mul_i32 s27, s27, 5120
  s_add_u32 s26, s4, s27
  s_and_b32 s5, s21, 1
  s_and_b32 s6, s23, 1
  s_lshl1_add_u32 s5, s5, s6
  s_lshl_b32 s28, s5, 10
  s_add_u32 s28, s28, s26
  s_lshl_b32 s29, s5, 8
  s_add_u32 s29, s29, s26
  s_add_u32 s29, s29, 4096
  s_mul_i32 s30, s5, -768
  s_add_u32 s30, s30, 3072
  s_add_u32 s5, s4, 5120
  s_add_u32 s6, s4, 10240
  s_add_u32 s7, s4, 15360
  ds_read_b32 v7, v152 offset:12
  ds_read_b128 v[16:19], v250
  s_mov_b32 exec_hi, 0
  ds_read_b64 v[228:229], v252 offset:1024
  ds_read_b64 v[230:231], v253 offset:1024
  s_mov_b64 exec, -1
  ds_read_b128 v[20:23], v251
  s_waitcnt lgkmcnt(0)
  v_mov_b32 v12, 0xff800000
  v_mov_b32 v15, 0xff800000
  s_mov_b32 s25, 0
A_fb_loop:
  buffer_load_dwordx4 v[28:31], v6, s[40:43], s25 offen sc1
  buffer_load_dwordx2 v[32:33], v147, s[40:43], s25 offen offset:1024 sc1
  s_waitcnt vmcnt(0)
  v_mfma_f32_32x32x16_bf16 v[56:71], v[28:31], v[16:19], 0
  v_mfma_f32_32x32x16_bf16 v[72:87], v[28:31], v[20:23], 0
  v_mfma_f32_32x32x8_bf16 v[56:71], v[32:33], v[228:229], v[56:71]
  v_mfma_f32_32x32x8_bf16 v[72:87], v[32:33], v[230:231], v[72:87]
  s_nop 15
  v_max3_f32 v12, v12, v56, v57
  v_max3_f32 v12, v12, v58, v59
  v_max3_f32 v12, v12, v60, v61
  v_max3_f32 v12, v12, v62, v63
  v_max3_f32 v12, v12, v64, v65
  v_max3_f32 v12, v12, v66, v67
  v_max3_f32 v12, v12, v68, v69
  v_max3_f32 v12, v12, v70, v71
  v_max3_f32 v15, v15, v72, v73
  v_max3_f32 v15, v15, v74, v75
  v_max3_f32 v15, v15, v76, v77
  v_max3_f32 v15, v15, v78, v79
  v_max3_f32 v15, v15, v80, v81
  v_max3_f32 v15, v15, v82, v83
  v_max3_f32 v15, v15, v84, v85
  v_max3_f32 v15, v15, v86, v87
  s_add_u32 s25, s25, 3072
  s_and_b32 s26, s25, 0x7fff
  s_cmp_eq_u32 s26, 24576
  s_cselect_b32 s26, 8192, 0
  s_add_u32 s25, s25, s26
  s_cmp_lt_u32 s25, 262144
  s_cbranch_scc1 A_fb_loop
  v_mov_b32 v10, v12
  v_mov_b32 v11, v12
  s_nop 1
  v_permlane32_swap_b32 v10, v11
  s_nop 1
  v_max_f32 v10, v10, v11
  v_sub_f32 v10, 0, v10
  v_and_b32 v11, 0xffff0000, v10
  v_sub_f32 v10, v10, v11
  v_and_b32 v9, 0xffff0000, v10
  v_sub_f32 v10, v10, v9
  v_lshrrev_b32 v11, 16, v11
  s_mov_b32 exec_lo, 0
  v_or_b32 v228, v11, v9
  v_lshrrev_b32 v229, 16, v10
  s_mov_b64 exec, -1
  v_mov_b32 v10, v15
  v_mov_b32 v11, v15
  s_nop 1
  v_permlane32_swap_b32 v10, v11
  s_nop 1
  v_max_f32 v10, v10, v11
  v_sub_f32 v10, 0, v10
  v_and_b32 v11, 0xffff0000, v10
  v_sub_f32 v10, v10, v11
  v_and_b32 v9, 0xffff0000, v10
  v_sub_f32 v10, v10, v9
  v_lshrrev_b32 v11, 16, v11
  s_mov_b32 exec_lo, 0
  v_or_b32 v230, v11, v9
  v_lshrrev_b32 v231, 16, v10
  s_mov_b64 exec, -1
  s_barrier
  s_lshl_b32 s25, s3, 15
  s_add_u32 m0, s50, 102400
  s_add_u32 s25, s25, s50
  buffer_load_dwordx4 v6, s[40:43], s25 offen sc1 lds
  buffer_load_dwordx4 v6, s[40:43], s25 offen offset:1024 sc1 lds
  buffer_load_dwordx4 v6, s[40:43], s25 offen offset:2048 sc1 lds
  v_mov_b32 v7, 0
  s_waitcnt vmcnt(0)
  s_barrier
  ds_read_b128 v[28:31], v232
  ds_read_b64 v[32:33], v233
  ds_read_b128 v[120:123], v234
  ds_read_b128 v[124:127], v234 offset:768
  s_waitcnt lgkmcnt(0)
  s_branch A_start
.section .rodata,"a"
.p2align 6
.amdhsa_kernel standalone__grouped_kv_mqa__prompt_kernel
  .amdhsa_next_free_vgpr 256
  .amdhsa_next_free_sgpr 102
  .amdhsa_accum_offset 256
  .amdhsa_group_segment_fixed_size 0
  .amdhsa_kernarg_size 64
  .amdhsa_user_sgpr_count 2
  .amdhsa_user_sgpr_kernarg_segment_ptr 1
  .amdhsa_system_sgpr_workgroup_id_x 1
.end_amdhsa_kernel
```
